```python
import torch

def _softmax(x, axis=-1):
    return torch.softmax(x, dim=axis)
def _gelu(x):
    return torch.nn.functional.gelu(x, approximate="tanh")
def _silu(x):
    return torch.nn.functional.silu(x)
def _sigmoid(x):
    return torch.sigmoid(x)
def _layernorm(x, axis=-1, eps=1e-5):
    m = x.mean(dim=axis, keepdim=True)
    v = x.var(dim=axis, keepdim=True, unbiased=False)
    return (x - m) / torch.sqrt(v + eps)
def _scatter_add(tgt, idx, src, axis=0):
    return tgt.clone().index_add_(axis, idx, src)
def _segment_sum(src, seg, n):
    out = torch.zeros((n,) + src.shape[1:], dtype=src.dtype)
    return out.index_add_(0, seg, src)
def _pad(x, pw):
    flat = tuple(v for pair in reversed(pw) for v in pair)
    return torch.nn.functional.pad(x, flat)

kernel_name = 'standalone__standard_2d_1d_3d_conv__vision'

def setup_inputs():

    _w = (lambda a: (lambda t: t.to(torch.bfloat16) if t.is_floating_point() else t)(torch.as_tensor(a)))
    H = W = 224
    C = 192
    K = 3
    return {
        "x": _w((lambda *s: torch.randn(*s, dtype=torch.bfloat16) * 0.05)(1, H, W, C)),
        "w": _w((lambda *s: torch.randn(*s, dtype=torch.bfloat16) * 0.05)(K, K, C, C)),
        "b": _w((lambda *s: torch.randn(*s, dtype=torch.bfloat16) * 0.05)(C)),
    }

def reference(x, w, b):
    B, H, W, Cin = x.shape
    K = w.shape[0]
    pl = (K - 1) // 2
    pr = K // 2
    xp = _pad(x, ((0, 0), (pl, pr), (pl, pr), (0, 0)))
    out = sum(
        torch.einsum('bhwc,cd->bhwd', xp[:, i:i+H, j:j+W, :], w[i, j])
        for i in range(K) for j in range(K)
    )
    return out + b[None, None, None, :]
```

```asm
; @launch grid=(256,1,1) block=(512,1,1) lds=163840
.amdgcn_target "amdgcn-amd-amdhsa--gfx950"
.text
.p2align 12
.fill 832, 4, 0xbf810000
.globl standalone__standard_2d_1d_3d_conv__vision_kernel
.p2align 8
.type standalone__standard_2d_1d_3d_conv__vision_kernel,@function
standalone__standard_2d_1d_3d_conv__vision_kernel:
  s_load_dwordx8 s[4:11], s[0:1], 0
  s_load_dwordx4 s[40:43], s[0:1], 32
  v_lshrrev_b32 v2, 6, v0
  v_and_b32 v1, 63, v0
  v_readfirstlane_b32 s28, v2
  s_cmp_ge_u32 s2, 256
  s_cbranch_scc1 L_end0
  s_cmp_lt_u32 s2, 32
  s_cbranch_scc1 L_help
  s_and_b32 s34, s2, 7
  s_mul_i32 s34, s34, 28
  s_lshr_b32 s35, s2, 3
  s_add_u32 s34, s34, s35
  s_sub_u32 s34, s34, 4
  s_mul_i32 s35, s34, 4682
  s_lshr_b32 s35, s35, 16
  s_mul_i32 s29, s35, 14
  s_sub_u32 s36, s34, s29
  s_lshl_b32 s30, s36, 4
  v_and_b32 v2, 3, v2
  s_lshr_b32 s36, s28, 2
  s_and_b32 s28, s28, 3
  s_mul_i32 s39, s28, 96
  s_mulk_i32 s28, 9216
  s_mov_b32 s33, s28
  s_cmp_lg_u32 s36, 1
  s_cbranch_scc1 L_prod
  v_mul_u32_u24 v50, 96, v2
  v_mul_u32_u24 v45, 10923, v1
  v_lshrrev_b32 v45, 16, v45
  v_mad_i32_i24 v46, v45, -6, v1
  v_lshl_add_u32 v46, v46, 4, v50
  v_and_b32 v47, 3, v45
  v_bfe_u32 v48, v45, 2, 2
  v_lshl_add_u32 v47, v48, 3, v47
  v_lshrrev_b32 v48, 4, v45
  v_lshl_add_u32 v47, v48, 2, v47
  v_mul_u32_u24 v47, 384, v47
  v_add_u32 v3, v47, v46
  v_add_u32 v44, 64, v1
  v_mul_u32_u24 v45, 10923, v44
  v_lshrrev_b32 v45, 16, v45
  v_mad_i32_i24 v46, v45, -6, v44
  v_lshl_add_u32 v46, v46, 4, v50
  v_and_b32 v47, 3, v45
  v_bfe_u32 v48, v45, 2, 2
  v_lshl_add_u32 v47, v48, 3, v47
  v_lshrrev_b32 v48, 4, v45
  v_lshl_add_u32 v47, v48, 2, v47
  v_mul_u32_u24 v47, 384, v47
  v_subrev_u32 v46, 1024, v46
  v_add_u32 v4, v47, v46
  v_add_u32 v44, 128, v1
  v_mul_u32_u24 v45, 10923, v44
  v_lshrrev_b32 v45, 16, v45
  v_mad_i32_i24 v46, v45, -6, v44
  v_lshl_add_u32 v46, v46, 4, v50
  v_and_b32 v47, 3, v45
  v_bfe_u32 v48, v45, 2, 2
  v_lshl_add_u32 v47, v48, 3, v47
  v_lshrrev_b32 v48, 4, v45
  v_lshl_add_u32 v47, v48, 2, v47
  v_mul_u32_u24 v47, 384, v47
  v_subrev_u32 v46, 2048, v46
  v_add_u32 v5, v47, v46
  s_setprio 1
  s_waitcnt lgkmcnt(0)
  s_mov_b32 s16, s6
  s_and_b32 s17, s7, 0xffff
  s_mov_b32 s18, 663552
  s_mov_b32 s19, 0x20000
  s_add_u32 m0, s33, 106752
  s_mov_b32 s34, 0
  buffer_load_dwordx4 v3, s[16:19], s34 offen offset:0 lds
  buffer_load_dwordx4 v4, s[16:19], s34 offen offset:1024 lds
  buffer_load_dwordx4 v5, s[16:19], s34 offen offset:2048 lds
  s_setprio 0
  s_branch L_cbody
L_help:
  s_cmp_lg_u32 s28, 7
  s_cbranch_scc1 L_hu
  s_lshr_b32 s34, s2, 3
  v_lshl_add_u32 v43, v1, 2, s34
  s_getpc_b64 s[52:53]
L_hpc:
  v_lshlrev_b32 v40, 7, v43
  v_min_u32 v40, L_end-L_hpc, v40
  v_mov_b32 v41, s53
  v_add_co_u32 v40, vcc, s52, v40
  s_nop 1
  v_addc_co_u32 v41, vcc, 0, v41, vcc
  global_load_dword v42, v[40:41], off
  v_lshlrev_b32 v43, 7, v43
  s_waitcnt lgkmcnt(0)
  s_mov_b32 s16, s6
  s_and_b32 s17, s7, 0xffff
  s_mov_b32 s18, 663552
  s_mov_b32 s19, 0x20000
  s_mov_b32 s35, 0
  buffer_load_dword v42, v43, s[16:19], s35 offen
  s_mov_b32 s35, 221184
  buffer_load_dword v42, v43, s[16:19], s35 offen
  s_mov_b32 s35, 442368
  buffer_load_dword v42, v43, s[16:19], s35 offen
  s_branch L_hw
L_hu:
  s_mul_i32 s34, s2, 432
  v_add_u32 v3, s34, v0
  v_cmp_gt_u32 vcc, 432, v0
  v_bfrev_b32 v7, 1
  v_mul_u32_u24 v4, 3641, v3
  v_lshrrev_b32 v4, 24, v4
  v_mul_u32_u24 v5, 147456, v4
  v_lshl_add_u32 v5, v3, 4, v5
  v_cndmask_b32 v5, v7, v5, vcc
  s_mov_b32 s35, 73728
  s_mov_b32 s36, 147456
  s_waitcnt lgkmcnt(0)
  s_mov_b32 s16, s6
  s_and_b32 s17, s7, 0xffff
  s_mov_b32 s18, 663552
  s_mov_b32 s19, 0x20000
  buffer_load_dwordx4 v[60:63], v5, s[16:19], 0 offen
  buffer_load_dwordx4 v[64:67], v5, s[16:19], s35 offen
  buffer_load_dwordx4 v[68:71], v5, s[16:19], s36 offen
  s_branch L_h1
L_end0:
  s_endpgm
L_prod:
  v_lshrrev_b32 v160, 4, v1
  v_lshl_add_u32 v160, v2, 2, v160
  v_bfe_u32 v161, v1, 3, 1
  v_and_b32 v162, 7, v1
  s_sub_u32 s34, s29, 1
  v_add_u32 v163, s34, v160
  v_lshl_add_u32 v164, v161, 3, s30
  v_cmp_le_i32 vcc, 0, v163
  v_mul_u32_u24 v165, 224, v163
  v_add_u32 v165, v165, v164
  v_mul_u32_u24 v165, 384, v165
  v_lshl_add_u32 v165, v162, 4, v165
  v_bfrev_b32 v166, 1
  v_cndmask_b32 v7, v166, v165, vcc
  v_cmp_lt_u32 vcc, 0, v164
  v_subrev_u32 v165, 384, v7
  v_add_u32 v167, 3072, v7
  v_cndmask_b32 v6, v166, v165, vcc
  v_cmp_gt_u32 vcc, 216, v164
  v_lshlrev_b32 v168, 9, v160
  v_lshl_add_u32 v168, v161, 8, v168
  v_cndmask_b32 v8, v166, v167, vcc
  s_waitcnt lgkmcnt(0)
  s_mov_b32 s12, s4
  s_and_b32 s13, s5, 0xffff
  s_mov_b32 s14, 19267584
  s_mov_b32 s15, 0x20000
  buffer_load_dwordx4 v[40:43], v6, s[12:15], 0 offen offset:0 nt
  buffer_load_dwordx4 v[48:51], v7, s[12:15], 0 offen offset:384 nt
  buffer_load_dwordx4 v[56:59], v7, s[12:15], 0 offen offset:1152 nt
  buffer_load_dwordx4 v[64:67], v7, s[12:15], 0 offen offset:1920 nt
  buffer_load_dwordx4 v[72:75], v7, s[12:15], 0 offen offset:2688 nt
  buffer_load_dwordx4 v[80:83], v6, s[12:15], 0 offen offset:128 nt
  buffer_load_dwordx4 v[88:91], v7, s[12:15], 0 offen offset:512 nt
  buffer_load_dwordx4 v[96:99], v7, s[12:15], 0 offen offset:1280 nt
  buffer_load_dwordx4 v[104:107], v7, s[12:15], 0 offen offset:2048 nt
  buffer_load_dwordx4 v[112:115], v7, s[12:15], 0 offen offset:2816 nt
L_first_kb_end:
  s_branch L_p1
  .p2align 10
L_p1:
  v_and_b32 v169, 3, v162
  v_lshlrev_b32 v161, 1, v161
  v_xor_b32 v169, v169, v161
  v_lshl_add_u32 v168, v169, 4, v168
  v_lshrrev_b32 v169, 2, v162
  v_mul_u32_u24 v169, 8256, v169
  v_add_u32 v9, v168, v169
  s_mov_b32 s16, s6
  s_and_b32 s17, s7, 0xffff
  s_mov_b32 s18, 663552
  s_mov_b32 s19, 0x20000
  s_mov_b32 s20, s10
  s_and_b32 s21, s11, 0xffff
  s_mov_b32 s22, 19267584
  s_mov_b32 s23, 0x20000
  s_mov_b32 s44, s42
  s_and_b32 s45, s43, 0xffff
  s_mov_b32 s46, 663552
  s_mov_b32 s47, 0x20000
  s_mov_b32 s48, s40
  s_and_b32 s49, s41, 0xffff
  s_mov_b32 s50, 256
  s_mov_b32 s51, 0x20000
  v_mul_u32_u24 v182, 96, v2
  v_mul_u32_u24 v177, 10923, v1
  v_lshrrev_b32 v177, 16, v177
  v_mad_i32_i24 v178, v177, -6, v1
  v_lshl_add_u32 v178, v178, 4, v182
  v_and_b32 v179, 3, v177
  v_bfe_u32 v180, v177, 2, 2
  v_lshl_add_u32 v179, v180, 3, v179
  v_lshrrev_b32 v180, 4, v177
  v_lshl_add_u32 v179, v180, 2, v179
  v_mul_u32_u24 v179, 384, v179
  v_add_u32 v3, v179, v178
  v_add_u32 v176, 64, v1
  v_mul_u32_u24 v177, 10923, v176
  v_lshrrev_b32 v177, 16, v177
  v_mad_i32_i24 v178, v177, -6, v176
  v_lshl_add_u32 v178, v178, 4, v182
  v_and_b32 v179, 3, v177
  v_bfe_u32 v180, v177, 2, 2
  v_lshl_add_u32 v179, v180, 3, v179
  v_lshrrev_b32 v180, 4, v177
  v_lshl_add_u32 v179, v180, 2, v179
  v_mul_u32_u24 v179, 384, v179
  v_subrev_u32 v178, 1024, v178
  v_add_u32 v4, v179, v178
  v_add_u32 v176, 128, v1
  v_mul_u32_u24 v177, 10923, v176
  v_lshrrev_b32 v177, 16, v177
  v_mad_i32_i24 v178, v177, -6, v176
  v_lshl_add_u32 v178, v178, 4, v182
  v_and_b32 v179, 3, v177
  v_bfe_u32 v180, v177, 2, 2
  v_lshl_add_u32 v179, v180, 3, v179
  v_lshrrev_b32 v180, 4, v177
  v_lshl_add_u32 v179, v180, 2, v179
  v_mul_u32_u24 v179, 384, v179
  v_subrev_u32 v178, 2048, v178
  v_add_u32 v5, v179, v178
  v_mul_u32_u24 v18, 3072, v2
  v_lshl_add_u32 v18, v1, 4, v18
  s_waitcnt vmcnt(9)
  v_lshlrev_b32 v176, 16, v40
  v_and_b32 v177, 0xffff0000, v40
  v_lshlrev_b32 v178, 16, v41
  v_and_b32 v179, 0xffff0000, v41
  v_lshlrev_b32 v180, 16, v42
  v_and_b32 v181, 0xffff0000, v42
  v_lshlrev_b32 v182, 16, v43
  v_and_b32 v183, 0xffff0000, v43
  s_waitcnt vmcnt(8)
  v_lshlrev_b32 v184, 16, v48
  v_and_b32 v185, 0xffff0000, v48
  v_lshlrev_b32 v186, 16, v49
  v_and_b32 v187, 0xffff0000, v49
  v_lshlrev_b32 v188, 16, v50
  v_and_b32 v189, 0xffff0000, v50
  v_lshlrev_b32 v190, 16, v51
  v_and_b32 v191, 0xffff0000, v51
  v_sub_f32 v36, v176, v184
  v_sub_f32 v37, v177, v185
  v_cvt_pk_bf16_f32 v20, v36, v37
  v_sub_f32 v38, v178, v186
  v_sub_f32 v39, v179, v187
  v_cvt_pk_bf16_f32 v21, v38, v39
  v_sub_f32 v36, v180, v188
  v_sub_f32 v37, v181, v189
  v_cvt_pk_bf16_f32 v22, v36, v37
  v_sub_f32 v38, v182, v190
  v_sub_f32 v39, v183, v191
  v_cvt_pk_bf16_f32 v23, v38, v39
  ds_write_b128 v9, v[20:23] offset:0
  s_waitcnt vmcnt(7)
  v_lshlrev_b32 v176, 16, v56
  v_and_b32 v177, 0xffff0000, v56
  v_lshlrev_b32 v178, 16, v57
  v_and_b32 v179, 0xffff0000, v57
  v_lshlrev_b32 v180, 16, v58
  v_and_b32 v181, 0xffff0000, v58
  v_lshlrev_b32 v182, 16, v59
  v_and_b32 v183, 0xffff0000, v59
  v_sub_f32 v36, v184, v176
  v_sub_f32 v37, v185, v177
  v_cvt_pk_bf16_f32 v24, v36, v37
  v_sub_f32 v38, v186, v178
  v_sub_f32 v39, v187, v179
  v_cvt_pk_bf16_f32 v25, v38, v39
  v_sub_f32 v36, v188, v180
  v_sub_f32 v37, v189, v181
  v_cvt_pk_bf16_f32 v26, v36, v37
  v_sub_f32 v38, v190, v182
  v_sub_f32 v39, v191, v183
  v_cvt_pk_bf16_f32 v27, v38, v39
  ds_write_b128 v9, v[24:27] offset:64
  s_waitcnt vmcnt(6)
  v_lshlrev_b32 v184, 16, v64
  v_and_b32 v185, 0xffff0000, v64
  v_lshlrev_b32 v186, 16, v65
  v_and_b32 v187, 0xffff0000, v65
  v_lshlrev_b32 v188, 16, v66
  v_and_b32 v189, 0xffff0000, v66
  v_lshlrev_b32 v190, 16, v67
  v_and_b32 v191, 0xffff0000, v67
  v_sub_f32 v36, v176, v184
  v_sub_f32 v37, v177, v185
  v_cvt_pk_bf16_f32 v28, v36, v37
  v_sub_f32 v38, v178, v186
  v_sub_f32 v39, v179, v187
  v_cvt_pk_bf16_f32 v29, v38, v39
  v_sub_f32 v36, v180, v188
  v_sub_f32 v37, v181, v189
  v_cvt_pk_bf16_f32 v30, v36, v37
  v_sub_f32 v38, v182, v190
  v_sub_f32 v39, v183, v191
  v_cvt_pk_bf16_f32 v31, v38, v39
  ds_write_b128 v9, v[28:31] offset:128
  s_waitcnt vmcnt(5)
  v_lshlrev_b32 v176, 16, v72
  v_and_b32 v177, 0xffff0000, v72
  v_lshlrev_b32 v178, 16, v73
  v_and_b32 v179, 0xffff0000, v73
  v_lshlrev_b32 v180, 16, v74
  v_and_b32 v181, 0xffff0000, v74
  v_lshlrev_b32 v182, 16, v75
  v_and_b32 v183, 0xffff0000, v75
  v_sub_f32 v36, v184, v176
  v_sub_f32 v37, v185, v177
  v_cvt_pk_bf16_f32 v32, v36, v37
  v_sub_f32 v38, v186, v178
  v_sub_f32 v39, v187, v179
  v_cvt_pk_bf16_f32 v33, v38, v39
  v_sub_f32 v36, v188, v180
  v_sub_f32 v37, v189, v181
  v_cvt_pk_bf16_f32 v34, v36, v37
  v_sub_f32 v38, v190, v182
  v_sub_f32 v39, v191, v183
  v_cvt_pk_bf16_f32 v35, v38, v39
  ds_write_b128 v9, v[32:35] offset:192
  s_waitcnt lgkmcnt(0)
  s_barrier
  s_branch L_pbody
L_h1:
  s_mov_b32 s44, s42
  s_and_b32 s45, s43, 0xffff
  s_mov_b32 s46, 663552
  s_mov_b32 s47, 0x20000
  s_mov_b32 s48, s40
  s_and_b32 s49, s41, 0xffff
  s_mov_b32 s50, 256
  s_mov_b32 s51, 0x20000
  s_mov_b32 s37, 221184
  s_mov_b32 s36, 442368
  v_mul_u32_u24 v8, 43691, v3
  v_lshrrev_b32 v8, 20, v8
  v_mul_u32_u24 v9, 24, v8
  v_sub_u32 v9, v3, v9
  v_mul_u32_u24 v10, 43, v9
  v_lshrrev_b32 v10, 8, v10
  v_mad_i32_i24 v9, v10, -6, v9
  v_lshrrev_b32 v11, 5, v8
  v_lshl_add_u32 v10, v11, 2, v10
  v_mul_u32_u24 v10, 3072, v10
  v_lshl_add_u32 v9, v9, 4, v10
  v_and_b32 v10, 3, v8
  v_bfe_u32 v11, v8, 3, 2
  v_lshl_add_u32 v10, v11, 2, v10
  v_bfe_u32 v11, v8, 2, 1
  v_lshl_add_u32 v10, v11, 4, v10
  v_mul_u32_u24 v10, 96, v10
  v_add_u32 v9, v9, v10
  v_cndmask_b32 v6, v7, v9, vcc
  s_waitcnt vmcnt(0)
  v_lshlrev_b32 v30, 16, v60
  v_lshlrev_b32 v31, 16, v64
  v_lshlrev_b32 v32, 16, v68
  v_add_f32 v30, v30, v32
  v_add_f32 v34, v30, v31
  v_sub_f32 v36, v30, v31
  v_and_b32 v30, 0xffff0000, v60
  v_and_b32 v31, 0xffff0000, v64
  v_and_b32 v32, 0xffff0000, v68
  v_add_f32 v30, v30, v32
  v_add_f32 v35, v30, v31
  v_sub_f32 v37, v30, v31
  v_cvt_pk_bf16_f32 v20, v34, v35
  v_cvt_pk_bf16_f32 v24, v36, v37
  v_lshlrev_b32 v30, 16, v61
  v_lshlrev_b32 v31, 16, v65
  v_lshlrev_b32 v32, 16, v69
  v_add_f32 v30, v30, v32
  v_add_f32 v34, v30, v31
  v_sub_f32 v36, v30, v31
  v_and_b32 v30, 0xffff0000, v61
  v_and_b32 v31, 0xffff0000, v65
  v_and_b32 v32, 0xffff0000, v69
  v_add_f32 v30, v30, v32
  v_add_f32 v35, v30, v31
  v_sub_f32 v37, v30, v31
  v_cvt_pk_bf16_f32 v21, v34, v35
  v_cvt_pk_bf16_f32 v25, v36, v37
  v_lshlrev_b32 v30, 16, v62
  v_lshlrev_b32 v31, 16, v66
  v_lshlrev_b32 v32, 16, v70
  v_add_f32 v30, v30, v32
  v_add_f32 v34, v30, v31
  v_sub_f32 v36, v30, v31
  v_and_b32 v30, 0xffff0000, v62
  v_and_b32 v31, 0xffff0000, v66
  v_and_b32 v32, 0xffff0000, v70
  v_add_f32 v30, v30, v32
  v_add_f32 v35, v30, v31
  v_sub_f32 v37, v30, v31
  v_cvt_pk_bf16_f32 v22, v34, v35
  v_cvt_pk_bf16_f32 v26, v36, v37
  v_lshlrev_b32 v30, 16, v63
  v_lshlrev_b32 v31, 16, v67
  v_lshlrev_b32 v32, 16, v71
  v_add_f32 v30, v30, v32
  v_add_f32 v34, v30, v31
  v_sub_f32 v36, v30, v31
  v_and_b32 v30, 0xffff0000, v63
  v_and_b32 v31, 0xffff0000, v67
  v_and_b32 v32, 0xffff0000, v71
  v_add_f32 v30, v30, v32
  v_add_f32 v35, v30, v31
  v_sub_f32 v37, v30, v31
  v_cvt_pk_bf16_f32 v23, v34, v35
  v_cvt_pk_bf16_f32 v27, v36, v37
  buffer_store_dwordx4 v[20:23], v6, s[44:47], 0 offen sc1
  buffer_store_dwordx4 v[24:27], v6, s[44:47], s37 offen sc1
  s_cmp_lg_u32 s28, 6
  s_cbranch_scc1 L_hn6
  s_lshr_b32 s34, s2, 3
  v_lshl_add_u32 v43, v1, 2, s34
  v_lshlrev_b32 v43, 7, v43
  s_mov_b32 s35, 32768
  buffer_load_dword v42, v43, s[16:19], s35 offen
  s_mov_b32 s35, 253952
  buffer_load_dword v42, v43, s[16:19], s35 offen
  s_mov_b32 s35, 475136
  buffer_load_dword v42, v43, s[16:19], s35 offen
  s_waitcnt vmcnt(3)
  s_branch L_hn7
L_hn6:
  s_waitcnt vmcnt(0)
L_hn7:
  s_barrier
  s_cmp_lg_u32 s28, 0
  s_cbranch_scc1 L_hsig
  v_mov_b32 v3, 0
  v_mov_b32 v4, 1
  s_lshl_b32 s34, s2, 2
  s_mov_b64 exec, 1
  buffer_store_dword v4, v3, s[48:51], s34 offen sc1
  s_mov_b64 exec, -1
L_hsig:
  s_endpgm
L_hw:
  v_add_u32 v40, 0x8000, v43
  v_min_u32 v40, L_end-L_hpc, v40
  v_mov_b32 v41, s53
  v_add_co_u32 v40, vcc, s52, v40
  s_nop 1
  v_addc_co_u32 v41, vcc, 0, v41, vcc
  global_load_dword v42, v[40:41], off
  s_mov_b32 s44, s42
  s_and_b32 s45, s43, 0xffff
  s_mov_b32 s46, 663552
  s_mov_b32 s47, 0x20000
  s_mov_b32 s48, s40
  s_and_b32 s49, s41, 0xffff
  s_mov_b32 s50, 256
  s_mov_b32 s51, 0x20000
  s_barrier
  s_mov_b32 s35, 65536
  buffer_load_dword v42, v43, s[16:19], s35 offen
  s_mov_b32 s35, 286720
  buffer_load_dword v42, v43, s[16:19], s35 offen
  s_mov_b32 s35, 507904
  buffer_load_dword v42, v43, s[16:19], s35 offen
  s_mov_b32 s35, 147456
  buffer_load_dword v42, v43, s[16:19], s35 offen
  s_mov_b32 s35, 368640
  buffer_load_dword v42, v43, s[16:19], s35 offen
  s_mov_b32 s35, 589824
  buffer_load_dword v42, v43, s[16:19], s35 offen
  s_mov_b32 s35, 180224
  buffer_load_dword v42, v43, s[16:19], s35 offen
  s_mov_b32 s35, 401408
  buffer_load_dword v42, v43, s[16:19], s35 offen
  s_mov_b32 s35, 622592
  buffer_load_dword v42, v43, s[16:19], s35 offen
  s_mov_b32 s35, 212992
  buffer_load_dword v42, v43, s[16:19], s35 offen
  s_mov_b32 s35, 434176
  buffer_load_dword v42, v43, s[16:19], s35 offen
  s_mov_b32 s35, 655360
  buffer_load_dword v42, v43, s[16:19], s35 offen
  s_endpgm
  .p2align 10
L_cbody:
  s_mov_b32 s32, 0
  s_mov_b32 s24, s8
  s_and_b32 s25, s9, 0xffff
  s_mov_b32 s26, 384
  s_mov_b32 s27, 0x20000
  v_lshrrev_b32 v51, 4, v1
  v_mul_u32_u24 v44, 24, v1
  v_add_u32 v44, s33, v44
  v_add_u32 v6, 33024, v44
  v_add_u32 v7, 106752, v44
  v_and_b32 v44, 15, v1
  v_lshrrev_b32 v46, 1, v44
  v_and_b32 v46, 2, v46
  v_xor_b32 v46, v46, v51
  v_lshlrev_b32 v46, 4, v46
  v_lshl_add_u32 v0, v44, 6, v46
  v_mul_u32_u24 v1, 24, v51
  v_add_u32 v1, s39, v1
  v_mul_u32_u24 v45, 392, v44
  v_add_u32 v45, v45, v1
  v_add_u32 v8, 137344, v45
  s_add_u32 m0, s33, 109824
  s_mov_b32 s34, 221184
  buffer_load_dwordx4 v3, s[16:19], s34 offen offset:0 lds
  buffer_load_dwordx4 v4, s[16:19], s34 offen offset:1024 lds
  buffer_load_dwordx4 v5, s[16:19], s34 offen offset:2048 lds
  s_add_u32 m0, s33, 112896
  s_mov_b32 s34, 442368
  buffer_load_dwordx4 v3, s[16:19], s34 offen offset:0 lds
  buffer_load_dwordx4 v4, s[16:19], s34 offen offset:1024 lds
  buffer_load_dwordx4 v5, s[16:19], s34 offen offset:2048 lds
  s_setprio 1
  s_barrier
  ds_read_b128 a[36:39], v0 offset:0
  ds_read_b128 a[40:43], v0 offset:1024
  ds_read_b128 a[44:47], v0 offset:2048
  s_waitcnt vmcnt(6)
  ds_read_b64_tr_b16 a[0:1], v7 offset:0
  ds_read_b64_tr_b16 a[2:3], v7 offset:1536
  ds_read_b64_tr_b16 a[4:5], v7 offset:8
  ds_read_b64_tr_b16 a[6:7], v7 offset:1544
  ds_read_b64_tr_b16 a[8:9], v7 offset:16
  ds_read_b64_tr_b16 a[10:11], v7 offset:1552
  s_waitcnt lgkmcnt(0)
  v_mfma_f32_16x16x32_bf16 v[28:31], a[0:3], a[36:39], 0
  ds_read_b128 a[48:51], v0 offset:3072
  v_mfma_f32_16x16x32_bf16 v[32:35], a[4:7], a[36:39], 0
  ds_read_b128 a[52:55], v0 offset:4096
  v_mfma_f32_16x16x32_bf16 v[36:39], a[8:11], a[36:39], 0
  v_mfma_f32_16x16x32_bf16 v[40:43], a[0:3], a[40:43], 0
  ds_read_b128 a[56:59], v0 offset:5120
  v_mfma_f32_16x16x32_bf16 v[44:47], a[4:7], a[40:43], 0
  ds_read_b128 v[12:15], v0 offset:6144
  v_mfma_f32_16x16x32_bf16 v[48:51], a[8:11], a[40:43], 0
  v_mfma_f32_16x16x32_bf16 v[52:55], a[0:3], a[44:47], 0
  ds_read_b128 v[16:19], v0 offset:512
  v_mfma_f32_16x16x32_bf16 v[56:59], a[4:7], a[44:47], 0
  v_mfma_f32_16x16x32_bf16 v[60:63], a[8:11], a[44:47], 0
  s_waitcnt lgkmcnt(4)
  v_mfma_f32_16x16x32_bf16 v[64:67], a[0:3], a[48:51], 0
  ds_read_b128 v[20:23], v0 offset:1536
  v_mfma_f32_16x16x32_bf16 v[68:71], a[4:7], a[48:51], 0
  s_add_u32 m0, s33, 69888
  s_mov_b32 s34, 12288
  buffer_load_dwordx4 v3, s[16:19], s34 offen offset:0 lds
  buffer_load_dwordx4 v4, s[16:19], s34 offen offset:1024 lds
  buffer_load_dwordx4 v5, s[16:19], s34 offen offset:2048 lds
  v_mfma_f32_16x16x32_bf16 v[72:75], a[8:11], a[48:51], 0
  s_waitcnt lgkmcnt(4)
  s_add_u32 m0, s33, 72960
  s_mov_b32 s34, 233472
  buffer_load_dwordx4 v3, s[16:19], s34 offen offset:0 lds
  buffer_load_dwordx4 v4, s[16:19], s34 offen offset:1024 lds
  v_mfma_f32_16x16x32_bf16 v[76:79], a[0:3], a[52:55], 0
  buffer_load_dwordx4 v5, s[16:19], s34 offen offset:2048 lds
  s_add_u32 m0, s33, 76032
  s_mov_b32 s34, 454656
  buffer_load_dwordx4 v3, s[16:19], s34 offen offset:0 lds
  buffer_load_dwordx4 v4, s[16:19], s34 offen offset:1024 lds
  v_mfma_f32_16x16x32_bf16 v[80:83], a[4:7], a[52:55], 0
  buffer_load_dwordx4 v5, s[16:19], s34 offen offset:2048 lds
  v_mfma_f32_16x16x32_bf16 v[84:87], a[8:11], a[52:55], 0
  s_waitcnt lgkmcnt(3)
  s_waitcnt vmcnt(12)
  ds_read_b64_tr_b16 a[12:13], v7 offset:3072
  v_mfma_f32_16x16x32_bf16 v[88:91], a[0:3], a[56:59], 0
  ds_read_b64_tr_b16 a[14:15], v7 offset:4608
  v_mfma_f32_16x16x32_bf16 v[92:95], a[4:7], a[56:59], 0
  ds_read_b64_tr_b16 a[16:17], v7 offset:3080
  v_mfma_f32_16x16x32_bf16 v[96:99], a[8:11], a[56:59], 0
  s_waitcnt lgkmcnt(5)
  ds_read_b64_tr_b16 a[18:19], v7 offset:4616
  v_mfma_f32_16x16x32_bf16 v[100:103], a[0:3], v[12:15], 0
  ds_read_b64_tr_b16 a[20:21], v7 offset:3088
  v_mfma_f32_16x16x32_bf16 v[104:107], a[4:7], v[12:15], 0
  ds_read_b64_tr_b16 a[22:23], v7 offset:4624
  ds_read_b128 v[24:27], v0 offset:2560
  v_mfma_f32_16x16x32_bf16 v[108:111], a[8:11], v[12:15], 0
  s_waitcnt lgkmcnt(1)
  v_mfma_f32_16x16x32_bf16 v[28:31], a[12:15], v[16:19], v[28:31]
  ds_read_b128 a[36:39], v0 offset:3584
  v_mfma_f32_16x16x32_bf16 v[32:35], a[16:19], v[16:19], v[32:35]
  ds_read_b128 a[40:43], v0 offset:4608
  v_mfma_f32_16x16x32_bf16 v[36:39], a[20:23], v[16:19], v[36:39]
  v_mfma_f32_16x16x32_bf16 v[40:43], a[12:15], v[20:23], v[40:43]
  ds_read_b128 a[44:47], v0 offset:5632
  v_mfma_f32_16x16x32_bf16 v[44:47], a[16:19], v[20:23], v[44:47]
  ds_read_b128 a[48:51], v0 offset:6656
  v_mfma_f32_16x16x32_bf16 v[48:51], a[20:23], v[20:23], v[48:51]
  s_waitcnt lgkmcnt(4)
  v_mfma_f32_16x16x32_bf16 v[52:55], a[12:15], v[24:27], v[52:55]
  ds_read_b128 a[52:55], v0 offset:1024
  v_mfma_f32_16x16x32_bf16 v[56:59], a[16:19], v[24:27], v[56:59]
  v_mfma_f32_16x16x32_bf16 v[60:63], a[20:23], v[24:27], v[60:63]
  s_waitcnt lgkmcnt(4)
  v_mfma_f32_16x16x32_bf16 v[64:67], a[12:15], a[36:39], v[64:67]
  ds_read_b128 a[56:59], v0 offset:2048
  v_mfma_f32_16x16x32_bf16 v[68:71], a[16:19], a[36:39], v[68:71]
  v_mfma_f32_16x16x32_bf16 v[72:75], a[20:23], a[36:39], v[72:75]
  s_waitcnt lgkmcnt(4)
  v_mfma_f32_16x16x32_bf16 v[76:79], a[12:15], a[40:43], v[76:79]
  ds_read_b128 v[12:15], v0 offset:3072
  v_mfma_f32_16x16x32_bf16 v[80:83], a[16:19], a[40:43], v[80:83]
  v_mfma_f32_16x16x32_bf16 v[84:87], a[20:23], a[40:43], v[84:87]
  s_waitcnt lgkmcnt(4)
  s_waitcnt vmcnt(9)
  ds_read_b64_tr_b16 a[24:25], v7 offset:6144
  v_mfma_f32_16x16x32_bf16 v[88:91], a[12:15], a[44:47], v[88:91]
  ds_read_b64_tr_b16 a[26:27], v7 offset:7680
  v_mfma_f32_16x16x32_bf16 v[92:95], a[16:19], a[44:47], v[92:95]
  ds_read_b64_tr_b16 a[28:29], v7 offset:6152
  v_mfma_f32_16x16x32_bf16 v[96:99], a[20:23], a[44:47], v[96:99]
  s_waitcnt lgkmcnt(6)
  ds_read_b64_tr_b16 a[30:31], v7 offset:7688
  v_mfma_f32_16x16x32_bf16 v[100:103], a[12:15], a[48:51], v[100:103]
  ds_read_b64_tr_b16 a[32:33], v7 offset:6160
  v_mfma_f32_16x16x32_bf16 v[104:107], a[16:19], a[48:51], v[104:107]
  ds_read_b64_tr_b16 a[34:35], v7 offset:7696
  v_mfma_f32_16x16x32_bf16 v[108:111], a[20:23], a[48:51], v[108:111]
  s_waitcnt lgkmcnt(0)
  v_mfma_f32_16x16x32_bf16 v[28:31], a[24:27], a[52:55], v[28:31]
  ds_read_b128 v[16:19], v0 offset:4096
  v_mfma_f32_16x16x32_bf16 v[32:35], a[28:31], a[52:55], v[32:35]
  ds_read_b128 v[20:23], v0 offset:5120
L_pg0:
  s_cmp_lg_u32 s32, 0
  s_cbranch_scc1 L_pr0
  v_mfma_f32_16x16x32_bf16 v[36:39], a[32:35], a[52:55], v[36:39]
  v_mfma_f32_16x16x32_bf16 v[40:43], a[24:27], a[56:59], v[40:43]
  ds_read_b128 v[24:27], v0 offset:6144
  v_mfma_f32_16x16x32_bf16 v[44:47], a[28:31], a[56:59], v[44:47]
  s_waitcnt vmcnt(6)
  ds_read_b64_tr_b16 a[0:1], v6 offset:36864
  v_mfma_f32_16x16x32_bf16 v[48:51], a[32:35], a[56:59], v[48:51]
  ds_read_b64_tr_b16 a[2:3], v6 offset:38400
  v_mfma_f32_16x16x32_bf16 v[52:55], a[24:27], v[12:15], v[52:55]
  ds_read_b64_tr_b16 a[4:5], v6 offset:36872
  v_mfma_f32_16x16x32_bf16 v[56:59], a[28:31], v[12:15], v[56:59]
  ds_read_b64_tr_b16 a[6:7], v6 offset:38408
  v_mfma_f32_16x16x32_bf16 v[60:63], a[32:35], v[12:15], v[60:63]
  s_waitcnt lgkmcnt(6)
  ds_read_b64_tr_b16 a[8:9], v6 offset:36880
  v_mfma_f32_16x16x32_bf16 v[64:67], a[24:27], v[16:19], v[64:67]
  ds_read_b64_tr_b16 a[10:11], v6 offset:38416
  v_mfma_f32_16x16x32_bf16 v[68:71], a[28:31], v[16:19], v[68:71]
  s_waitcnt vmcnt(3)
  ds_read_b64_tr_b16 a[12:13], v6 offset:39936
  ds_read_b128 a[36:39], v0 offset:7168
  v_mfma_f32_16x16x32_bf16 v[72:75], a[32:35], v[16:19], v[72:75]
  s_waitcnt lgkmcnt(9)
  ds_read_b64_tr_b16 a[14:15], v6 offset:41472
  v_mfma_f32_16x16x32_bf16 v[76:79], a[24:27], v[20:23], v[76:79]
  ds_read_b64_tr_b16 a[16:17], v6 offset:39944
  v_mfma_f32_16x16x32_bf16 v[80:83], a[28:31], v[20:23], v[80:83]
  ds_read_b64_tr_b16 a[18:19], v6 offset:41480
  ds_read_b128 a[40:43], v0 offset:8256
  v_mfma_f32_16x16x32_bf16 v[84:87], a[32:35], v[20:23], v[84:87]
  s_waitcnt lgkmcnt(12)
  ds_read_b64_tr_b16 a[20:21], v6 offset:39952
  v_mfma_f32_16x16x32_bf16 v[88:91], a[24:27], v[24:27], v[88:91]
  ds_read_b64_tr_b16 a[22:23], v6 offset:41488
  v_mfma_f32_16x16x32_bf16 v[92:95], a[28:31], v[24:27], v[92:95]
  ds_read_b128 a[44:47], v0 offset:9280
  v_mfma_f32_16x16x32_bf16 v[96:99], a[32:35], v[24:27], v[96:99]
  s_waitcnt lgkmcnt(7)
  v_mfma_f32_16x16x32_bf16 v[100:103], a[24:27], a[36:39], v[100:103]
  s_waitcnt vmcnt(0)
  ds_read_b64_tr_b16 a[24:25], v6 offset:43008
  v_mfma_f32_16x16x32_bf16 v[104:107], a[28:31], a[36:39], v[104:107]
  ds_read_b64_tr_b16 a[26:27], v6 offset:44544
  ds_read_b128 a[48:51], v0 offset:8768
  v_mfma_f32_16x16x32_bf16 v[108:111], a[32:35], a[36:39], v[108:111]
  s_waitcnt lgkmcnt(6)
  ds_read_b64_tr_b16 a[28:29], v6 offset:43016
  v_mfma_f32_16x16x32_bf16 v[28:31], a[0:3], a[40:43], v[28:31]
  ds_read_b64_tr_b16 a[30:31], v6 offset:44552
  v_mfma_f32_16x16x32_bf16 v[32:35], a[4:7], a[40:43], v[32:35]
  ds_read_b64_tr_b16 a[32:33], v6 offset:43024
  ds_read_b128 a[52:55], v0 offset:9792
  v_mfma_f32_16x16x32_bf16 v[36:39], a[8:11], a[40:43], v[36:39]
  s_waitcnt lgkmcnt(7)
  ds_read_b64_tr_b16 a[34:35], v6 offset:44560
  v_mfma_f32_16x16x32_bf16 v[40:43], a[0:3], a[44:47], v[40:43]
  ds_read_b128 a[56:59], v0 offset:10304
  v_mfma_f32_16x16x32_bf16 v[44:47], a[4:7], a[44:47], v[44:47]
  ds_read_b128 v[12:15], v0 offset:10816
  v_mfma_f32_16x16x32_bf16 v[48:51], a[8:11], a[44:47], v[48:51]
  s_waitcnt lgkmcnt(7)
  v_mfma_f32_16x16x32_bf16 v[28:31], a[12:15], a[48:51], v[28:31]
  ds_read_b128 v[16:19], v0 offset:11328
  v_mfma_f32_16x16x32_bf16 v[32:35], a[16:19], a[48:51], v[32:35]
  v_mfma_f32_16x16x32_bf16 v[36:39], a[20:23], a[48:51], v[36:39]
  s_waitcnt lgkmcnt(4)
  v_mfma_f32_16x16x32_bf16 v[40:43], a[12:15], a[52:55], v[40:43]
  v_mfma_f32_16x16x32_bf16 v[44:47], a[16:19], a[52:55], v[44:47]
  v_mfma_f32_16x16x32_bf16 v[48:51], a[20:23], a[52:55], v[48:51]
  s_waitcnt lgkmcnt(3)
  v_mfma_f32_16x16x32_bf16 v[28:31], a[24:27], a[44:47], v[28:31]
  v_mfma_f32_16x16x32_bf16 v[32:35], a[28:31], a[44:47], v[32:35]
  ds_read_b128 v[20:23], v0 offset:11840
  v_mfma_f32_16x16x32_bf16 v[36:39], a[32:35], a[44:47], v[36:39]
  s_waitcnt lgkmcnt(3)
  v_mfma_f32_16x16x32_bf16 v[40:43], a[24:27], a[56:59], v[40:43]
  ds_read_b128 v[24:27], v0 offset:12352
  v_mfma_f32_16x16x32_bf16 v[44:47], a[28:31], a[56:59], v[44:47]
  v_mfma_f32_16x16x32_bf16 v[48:51], a[32:35], a[56:59], v[48:51]
  v_mfma_f32_16x16x32_bf16 v[52:55], a[0:3], a[56:59], v[52:55]
  s_waitcnt lgkmcnt(2)
  v_mfma_f32_16x16x32_bf16 v[52:55], a[12:15], v[12:15], v[52:55]
  v_mfma_f32_16x16x32_bf16 v[52:55], a[24:27], v[16:19], v[52:55]
  s_barrier
  v_mfma_f32_16x16x32_bf16 v[56:59], a[28:31], v[16:19], v[56:59]
  v_mfma_f32_16x16x32_bf16 v[56:59], a[16:19], v[12:15], v[56:59]
  ds_read_b128 a[36:39], v0 offset:12864
  v_mfma_f32_16x16x32_bf16 v[56:59], a[4:7], a[56:59], v[56:59]
  ds_read_b128 a[40:43], v0 offset:13376
  v_mfma_f32_16x16x32_bf16 v[60:63], a[8:11], a[56:59], v[60:63]
  v_mfma_f32_16x16x32_bf16 v[60:63], a[20:23], v[12:15], v[60:63]
  v_mfma_f32_16x16x32_bf16 v[60:63], a[32:35], v[16:19], v[60:63]
  v_mfma_f32_16x16x32_bf16 v[64:67], a[0:3], v[16:19], v[64:67]
  s_waitcnt lgkmcnt(2)
  v_mfma_f32_16x16x32_bf16 v[64:67], a[12:15], v[20:23], v[64:67]
  v_mfma_f32_16x16x32_bf16 v[64:67], a[24:27], v[24:27], v[64:67]
  v_mfma_f32_16x16x32_bf16 v[68:71], a[28:31], v[24:27], v[68:71]
  v_mfma_f32_16x16x32_bf16 v[68:71], a[16:19], v[20:23], v[68:71]
  ds_read_b128 a[48:51], v0 offset:13888
  v_mfma_f32_16x16x32_bf16 v[68:71], a[4:7], v[16:19], v[68:71]
  ds_read_b128 a[52:55], v0 offset:14400
  v_mfma_f32_16x16x32_bf16 v[72:75], a[8:11], v[16:19], v[72:75]
  ds_read_b128 a[44:47], v0 offset:14912
  v_mfma_f32_16x16x32_bf16 v[72:75], a[20:23], v[20:23], v[72:75]
  ds_read_b128 a[56:59], v0 offset:15424
  v_mfma_f32_16x16x32_bf16 v[72:75], a[32:35], v[24:27], v[72:75]
  v_mfma_f32_16x16x32_bf16 v[76:79], a[0:3], v[24:27], v[76:79]
  s_waitcnt lgkmcnt(4)
  v_mfma_f32_16x16x32_bf16 v[76:79], a[12:15], a[36:39], v[76:79]
  v_mfma_f32_16x16x32_bf16 v[76:79], a[24:27], a[40:43], v[76:79]
  v_mfma_f32_16x16x32_bf16 v[80:83], a[28:31], a[40:43], v[80:83]
  v_mfma_f32_16x16x32_bf16 v[80:83], a[16:19], a[36:39], v[80:83]
  v_mfma_f32_16x16x32_bf16 v[80:83], a[4:7], v[24:27], v[80:83]
  v_mfma_f32_16x16x32_bf16 v[84:87], a[8:11], v[24:27], v[84:87]
  s_barrier
  v_mfma_f32_16x16x32_bf16 v[84:87], a[20:23], a[36:39], v[84:87]
  ds_read_b128 v[12:15], v0 offset:16512
  v_mfma_f32_16x16x32_bf16 v[84:87], a[32:35], a[40:43], v[84:87]
  ds_read_b128 v[16:19], v0 offset:17024
  v_mfma_f32_16x16x32_bf16 v[88:91], a[0:3], a[40:43], v[88:91]
  s_waitcnt lgkmcnt(2)
  v_mfma_f32_16x16x32_bf16 v[88:91], a[12:15], a[48:51], v[88:91]
  ds_read_b128 v[20:23], v0 offset:17536
  v_mfma_f32_16x16x32_bf16 v[88:91], a[24:27], a[52:55], v[88:91]
  ds_read_b128 v[24:27], v0 offset:18048
  v_mfma_f32_16x16x32_bf16 v[100:103], a[0:3], a[52:55], v[100:103]
  ds_read_b64_tr_b16 a[0:1], v6 offset:0
  v_mfma_f32_16x16x32_bf16 v[100:103], a[12:15], a[44:47], v[100:103]
  ds_read_b64_tr_b16 a[2:3], v6 offset:1536
  v_mfma_f32_16x16x32_bf16 v[100:103], a[24:27], a[56:59], v[100:103]
  ds_read_b64_tr_b16 a[12:13], v6 offset:3072
  v_mfma_f32_16x16x32_bf16 v[104:107], a[28:31], a[56:59], v[104:107]
  ds_read_b64_tr_b16 a[14:15], v6 offset:4608
  v_mfma_f32_16x16x32_bf16 v[104:107], a[16:19], a[44:47], v[104:107]
  ds_read_b64_tr_b16 a[24:25], v6 offset:6144
  v_mfma_f32_16x16x32_bf16 v[104:107], a[4:7], a[52:55], v[104:107]
  ds_read_b64_tr_b16 a[26:27], v6 offset:7680
  v_mfma_f32_16x16x32_bf16 v[92:95], a[28:31], a[52:55], v[92:95]
  ds_read_b64_tr_b16 a[28:29], v6 offset:6152
  v_mfma_f32_16x16x32_bf16 v[92:95], a[16:19], a[48:51], v[92:95]
  ds_read_b64_tr_b16 a[30:31], v6 offset:7688
  ds_read_b128 a[36:39], v0 offset:18560
  v_mfma_f32_16x16x32_bf16 v[92:95], a[4:7], a[40:43], v[92:95]
  ds_read_b64_tr_b16 a[16:17], v6 offset:3080
  v_mfma_f32_16x16x32_bf16 v[96:99], a[8:11], a[40:43], v[96:99]
  ds_read_b64_tr_b16 a[18:19], v6 offset:4616
  v_mfma_f32_16x16x32_bf16 v[96:99], a[20:23], a[48:51], v[96:99]
  ds_read_b64_tr_b16 a[4:5], v6 offset:8
  v_mfma_f32_16x16x32_bf16 v[96:99], a[32:35], a[52:55], v[96:99]
  ds_read_b64_tr_b16 a[6:7], v6 offset:1544
  v_mfma_f32_16x16x32_bf16 v[108:111], a[8:11], a[52:55], v[108:111]
  ds_read_b64_tr_b16 a[8:9], v6 offset:16
  v_mfma_f32_16x16x32_bf16 v[108:111], a[20:23], a[44:47], v[108:111]
  ds_read_b64_tr_b16 a[10:11], v6 offset:1552
  v_mfma_f32_16x16x32_bf16 v[108:111], a[32:35], a[56:59], v[108:111]
  s_waitcnt lgkmcnt(6)
  ds_read_b64_tr_b16 a[20:21], v6 offset:3088
  v_mfma_f32_16x16x32_bf16 v[28:31], a[0:3], v[12:15], v[28:31]
  ds_read_b64_tr_b16 a[22:23], v6 offset:4624
  v_mfma_f32_16x16x32_bf16 v[28:31], a[12:15], v[16:19], v[28:31]
  ds_read_b64_tr_b16 a[32:33], v6 offset:6160
  v_mfma_f32_16x16x32_bf16 v[28:31], a[24:27], v[20:23], v[28:31]
  ds_read_b64_tr_b16 a[34:35], v6 offset:7696
  v_mfma_f32_16x16x32_bf16 v[40:43], a[0:3], v[20:23], v[40:43]
  v_mfma_f32_16x16x32_bf16 v[40:43], a[12:15], v[24:27], v[40:43]
  ds_read_b128 a[40:43], v0 offset:19072
  v_mfma_f32_16x16x32_bf16 v[40:43], a[24:27], a[36:39], v[40:43]
  s_waitcnt lgkmcnt(7)
  v_mfma_f32_16x16x32_bf16 v[44:47], a[28:31], a[36:39], v[44:47]
  ds_read_b128 a[48:51], v0 offset:19584
  v_mfma_f32_16x16x32_bf16 v[44:47], a[16:19], v[24:27], v[44:47]
  v_mfma_f32_16x16x32_bf16 v[44:47], a[4:7], v[20:23], v[44:47]
  v_mfma_f32_16x16x32_bf16 v[32:35], a[28:31], v[20:23], v[32:35]
  v_mfma_f32_16x16x32_bf16 v[32:35], a[16:19], v[16:19], v[32:35]
  v_mfma_f32_16x16x32_bf16 v[32:35], a[4:7], v[12:15], v[32:35]
  s_waitcnt lgkmcnt(2)
  v_mfma_f32_16x16x32_bf16 v[36:39], a[8:11], v[12:15], v[36:39]
  v_mfma_f32_16x16x32_bf16 v[36:39], a[20:23], v[16:19], v[36:39]
  ds_read_b128 a[52:55], v0 offset:20096
  v_mfma_f32_16x16x32_bf16 v[36:39], a[32:35], v[20:23], v[36:39]
  ds_read_b128 a[44:47], v0 offset:20608
  v_mfma_f32_16x16x32_bf16 v[48:51], a[8:11], v[20:23], v[48:51]
  v_mfma_f32_16x16x32_bf16 v[48:51], a[20:23], v[24:27], v[48:51]
  v_mfma_f32_16x16x32_bf16 v[48:51], a[32:35], a[36:39], v[48:51]
  v_mfma_f32_16x16x32_bf16 v[52:55], a[0:3], a[36:39], v[52:55]
  s_waitcnt lgkmcnt(2)
  v_mfma_f32_16x16x32_bf16 v[52:55], a[12:15], a[40:43], v[52:55]
  v_mfma_f32_16x16x32_bf16 v[52:55], a[24:27], a[48:51], v[52:55]
  v_mfma_f32_16x16x32_bf16 v[56:59], a[28:31], a[48:51], v[56:59]
  v_mfma_f32_16x16x32_bf16 v[56:59], a[16:19], a[40:43], v[56:59]
  ds_read_b128 a[56:59], v0 offset:21120
  v_mfma_f32_16x16x32_bf16 v[56:59], a[4:7], a[36:39], v[56:59]
  ds_read_b128 v[12:15], v0 offset:21632
  v_mfma_f32_16x16x32_bf16 v[60:63], a[8:11], a[36:39], v[60:63]
  v_mfma_f32_16x16x32_bf16 v[60:63], a[20:23], a[40:43], v[60:63]
  v_mfma_f32_16x16x32_bf16 v[60:63], a[32:35], a[48:51], v[60:63]
  v_mfma_f32_16x16x32_bf16 v[64:67], a[0:3], a[48:51], v[64:67]
  s_waitcnt lgkmcnt(2)
  v_mfma_f32_16x16x32_bf16 v[64:67], a[12:15], a[52:55], v[64:67]
  v_mfma_f32_16x16x32_bf16 v[64:67], a[24:27], a[44:47], v[64:67]
  v_mfma_f32_16x16x32_bf16 v[68:71], a[28:31], a[44:47], v[68:71]
  v_mfma_f32_16x16x32_bf16 v[68:71], a[16:19], a[52:55], v[68:71]
  ds_read_b128 v[16:19], v0 offset:22144
  v_mfma_f32_16x16x32_bf16 v[68:71], a[4:7], a[48:51], v[68:71]
  ds_read_b128 v[20:23], v0 offset:22656
  v_mfma_f32_16x16x32_bf16 v[72:75], a[8:11], a[48:51], v[72:75]
  ds_read_b128 v[24:27], v0 offset:23168
  v_mfma_f32_16x16x32_bf16 v[72:75], a[20:23], a[52:55], v[72:75]
  ds_read_b128 a[36:39], v0 offset:23680
  v_mfma_f32_16x16x32_bf16 v[72:75], a[32:35], a[44:47], v[72:75]
  v_mfma_f32_16x16x32_bf16 v[76:79], a[0:3], a[44:47], v[76:79]
  s_waitcnt lgkmcnt(4)
  v_mfma_f32_16x16x32_bf16 v[76:79], a[12:15], a[56:59], v[76:79]
  v_mfma_f32_16x16x32_bf16 v[76:79], a[24:27], v[12:15], v[76:79]
  v_mfma_f32_16x16x32_bf16 v[80:83], a[28:31], v[12:15], v[80:83]
  v_mfma_f32_16x16x32_bf16 v[80:83], a[16:19], a[56:59], v[80:83]
  v_mfma_f32_16x16x32_bf16 v[80:83], a[4:7], a[44:47], v[80:83]
  v_mfma_f32_16x16x32_bf16 v[84:87], a[8:11], a[44:47], v[84:87]
  s_barrier
  v_mfma_f32_16x16x32_bf16 v[84:87], a[20:23], a[56:59], v[84:87]
  ds_read_b128 a[40:43], v0 offset:24768
  v_mfma_f32_16x16x32_bf16 v[84:87], a[32:35], v[12:15], v[84:87]
  ds_read_b128 a[48:51], v0 offset:25280
  v_mfma_f32_16x16x32_bf16 v[88:91], a[0:3], v[12:15], v[88:91]
  s_waitcnt lgkmcnt(2)
  v_mfma_f32_16x16x32_bf16 v[88:91], a[12:15], v[16:19], v[88:91]
  ds_read_b128 a[52:55], v0 offset:25792
  v_mfma_f32_16x16x32_bf16 v[88:91], a[24:27], v[20:23], v[88:91]
  ds_read_b128 a[44:47], v0 offset:26304
  v_mfma_f32_16x16x32_bf16 v[100:103], a[0:3], v[20:23], v[100:103]
  ds_read_b64_tr_b16 a[0:1], v7 offset:0
  v_mfma_f32_16x16x32_bf16 v[100:103], a[12:15], v[24:27], v[100:103]
  ds_read_b64_tr_b16 a[2:3], v7 offset:1536
  v_mfma_f32_16x16x32_bf16 v[100:103], a[24:27], a[36:39], v[100:103]
  ds_read_b64_tr_b16 a[12:13], v7 offset:3072
  v_mfma_f32_16x16x32_bf16 v[104:107], a[28:31], a[36:39], v[104:107]
  ds_read_b64_tr_b16 a[14:15], v7 offset:4608
  v_mfma_f32_16x16x32_bf16 v[104:107], a[16:19], v[24:27], v[104:107]
  ds_read_b64_tr_b16 a[24:25], v7 offset:6144
  v_mfma_f32_16x16x32_bf16 v[104:107], a[4:7], v[20:23], v[104:107]
  ds_read_b64_tr_b16 a[26:27], v7 offset:7680
  v_mfma_f32_16x16x32_bf16 v[92:95], a[28:31], v[20:23], v[92:95]
  ds_read_b64_tr_b16 a[28:29], v7 offset:6152
  v_mfma_f32_16x16x32_bf16 v[92:95], a[16:19], v[16:19], v[92:95]
  ds_read_b64_tr_b16 a[30:31], v7 offset:7688
  ds_read_b128 a[56:59], v0 offset:26816
  v_mfma_f32_16x16x32_bf16 v[92:95], a[4:7], v[12:15], v[92:95]
  ds_read_b64_tr_b16 a[16:17], v7 offset:3080
  v_mfma_f32_16x16x32_bf16 v[96:99], a[8:11], v[12:15], v[96:99]
  ds_read_b64_tr_b16 a[18:19], v7 offset:4616
  v_mfma_f32_16x16x32_bf16 v[96:99], a[20:23], v[16:19], v[96:99]
  ds_read_b64_tr_b16 a[4:5], v7 offset:8
  v_mfma_f32_16x16x32_bf16 v[96:99], a[32:35], v[20:23], v[96:99]
  ds_read_b64_tr_b16 a[6:7], v7 offset:1544
  v_mfma_f32_16x16x32_bf16 v[108:111], a[8:11], v[20:23], v[108:111]
  ds_read_b64_tr_b16 a[8:9], v7 offset:16
  v_mfma_f32_16x16x32_bf16 v[108:111], a[20:23], v[24:27], v[108:111]
  ds_read_b64_tr_b16 a[10:11], v7 offset:1552
  v_mfma_f32_16x16x32_bf16 v[108:111], a[32:35], a[36:39], v[108:111]
  s_waitcnt lgkmcnt(6)
  ds_read_b64_tr_b16 a[20:21], v7 offset:3088
  v_mfma_f32_16x16x32_bf16 v[28:31], a[0:3], a[40:43], v[28:31]
  ds_read_b64_tr_b16 a[22:23], v7 offset:4624
  v_mfma_f32_16x16x32_bf16 v[28:31], a[12:15], a[48:51], v[28:31]
  ds_read_b64_tr_b16 a[32:33], v7 offset:6160
  v_mfma_f32_16x16x32_bf16 v[28:31], a[24:27], a[52:55], v[28:31]
  ds_read_b64_tr_b16 a[34:35], v7 offset:7696
  v_mfma_f32_16x16x32_bf16 v[40:43], a[0:3], a[52:55], v[40:43]
  ds_read_b128 v[12:15], v0 offset:27328
  ds_read_b128 v[16:19], v0 offset:27840
  v_mfma_f32_16x16x32_bf16 v[40:43], a[12:15], a[44:47], v[40:43]
  ds_read_b128 v[20:23], v0 offset:28352
  ds_read_b128 v[24:27], v0 offset:28864
  v_mfma_f32_16x16x32_bf16 v[40:43], a[24:27], a[56:59], v[40:43]
  s_waitcnt lgkmcnt(10)
  v_mfma_f32_16x16x32_bf16 v[44:47], a[28:31], a[56:59], v[44:47]
  v_mfma_f32_16x16x32_bf16 v[44:47], a[16:19], a[44:47], v[44:47]
  v_mfma_f32_16x16x32_bf16 v[44:47], a[4:7], a[52:55], v[44:47]
  v_mfma_f32_16x16x32_bf16 v[32:35], a[28:31], a[52:55], v[32:35]
  s_barrier
  v_mfma_f32_16x16x32_bf16 v[32:35], a[16:19], a[48:51], v[32:35]
  v_mfma_f32_16x16x32_bf16 v[32:35], a[4:7], a[40:43], v[32:35]
  s_waitcnt lgkmcnt(4)
  v_mfma_f32_16x16x32_bf16 v[36:39], a[8:11], a[40:43], v[36:39]
  v_mfma_f32_16x16x32_bf16 v[36:39], a[20:23], a[48:51], v[36:39]
  v_mfma_f32_16x16x32_bf16 v[36:39], a[32:35], a[52:55], v[36:39]
  v_mfma_f32_16x16x32_bf16 v[48:51], a[8:11], a[52:55], v[48:51]
  v_mfma_f32_16x16x32_bf16 v[48:51], a[20:23], a[44:47], v[48:51]
  v_mfma_f32_16x16x32_bf16 v[48:51], a[32:35], a[56:59], v[48:51]
  v_mfma_f32_16x16x32_bf16 v[52:55], a[0:3], a[56:59], v[52:55]
  s_waitcnt lgkmcnt(2)
  v_mfma_f32_16x16x32_bf16 v[52:55], a[12:15], v[12:15], v[52:55]
  v_mfma_f32_16x16x32_bf16 v[52:55], a[24:27], v[16:19], v[52:55]
  v_mfma_f32_16x16x32_bf16 v[56:59], a[28:31], v[16:19], v[56:59]
  v_mfma_f32_16x16x32_bf16 v[56:59], a[16:19], v[12:15], v[56:59]
  ds_read_b128 a[36:39], v0 offset:29376
  v_mfma_f32_16x16x32_bf16 v[56:59], a[4:7], a[56:59], v[56:59]
  ds_read_b128 a[40:43], v0 offset:29888
  v_mfma_f32_16x16x32_bf16 v[60:63], a[8:11], a[56:59], v[60:63]
  v_mfma_f32_16x16x32_bf16 v[60:63], a[20:23], v[12:15], v[60:63]
  v_mfma_f32_16x16x32_bf16 v[60:63], a[32:35], v[16:19], v[60:63]
  v_mfma_f32_16x16x32_bf16 v[64:67], a[0:3], v[16:19], v[64:67]
  s_waitcnt lgkmcnt(2)
  v_mfma_f32_16x16x32_bf16 v[64:67], a[12:15], v[20:23], v[64:67]
  v_mfma_f32_16x16x32_bf16 v[64:67], a[24:27], v[24:27], v[64:67]
  v_mfma_f32_16x16x32_bf16 v[68:71], a[28:31], v[24:27], v[68:71]
  v_mfma_f32_16x16x32_bf16 v[68:71], a[16:19], v[20:23], v[68:71]
  ds_read_b128 a[48:51], v0 offset:30400
  v_mfma_f32_16x16x32_bf16 v[68:71], a[4:7], v[16:19], v[68:71]
  ds_read_b128 a[52:55], v0 offset:30912
  v_mfma_f32_16x16x32_bf16 v[72:75], a[8:11], v[16:19], v[72:75]
  ds_read_b128 a[44:47], v0 offset:31424
  v_mfma_f32_16x16x32_bf16 v[72:75], a[20:23], v[20:23], v[72:75]
  ds_read_b128 a[56:59], v0 offset:31936
  v_mfma_f32_16x16x32_bf16 v[72:75], a[32:35], v[24:27], v[72:75]
  v_mfma_f32_16x16x32_bf16 v[76:79], a[0:3], v[24:27], v[76:79]
  s_waitcnt lgkmcnt(4)
  v_mfma_f32_16x16x32_bf16 v[76:79], a[12:15], a[36:39], v[76:79]
  v_mfma_f32_16x16x32_bf16 v[76:79], a[24:27], a[40:43], v[76:79]
  v_mfma_f32_16x16x32_bf16 v[80:83], a[28:31], a[40:43], v[80:83]
  v_mfma_f32_16x16x32_bf16 v[80:83], a[16:19], a[36:39], v[80:83]
  v_mfma_f32_16x16x32_bf16 v[80:83], a[4:7], v[24:27], v[80:83]
  v_mfma_f32_16x16x32_bf16 v[84:87], a[8:11], v[24:27], v[84:87]
  s_barrier
  v_mfma_f32_16x16x32_bf16 v[84:87], a[20:23], a[36:39], v[84:87]
  ds_read_b128 v[12:15], v0 offset:0
  v_mfma_f32_16x16x32_bf16 v[84:87], a[32:35], a[40:43], v[84:87]
  ds_read_b128 v[16:19], v0 offset:512
  v_mfma_f32_16x16x32_bf16 v[88:91], a[0:3], a[40:43], v[88:91]
  s_waitcnt lgkmcnt(2)
  v_mfma_f32_16x16x32_bf16 v[88:91], a[12:15], a[48:51], v[88:91]
  ds_read_b128 v[20:23], v0 offset:1024
  v_mfma_f32_16x16x32_bf16 v[88:91], a[24:27], a[52:55], v[88:91]
  ds_read_b128 v[24:27], v0 offset:1536
  v_mfma_f32_16x16x32_bf16 v[100:103], a[0:3], a[52:55], v[100:103]
  ds_read_b64_tr_b16 a[0:1], v6 offset:36864
  v_mfma_f32_16x16x32_bf16 v[100:103], a[12:15], a[44:47], v[100:103]
  ds_read_b64_tr_b16 a[2:3], v6 offset:38400
  v_mfma_f32_16x16x32_bf16 v[100:103], a[24:27], a[56:59], v[100:103]
  ds_read_b64_tr_b16 a[12:13], v6 offset:39936
  v_mfma_f32_16x16x32_bf16 v[104:107], a[28:31], a[56:59], v[104:107]
  ds_read_b64_tr_b16 a[14:15], v6 offset:41472
  v_mfma_f32_16x16x32_bf16 v[104:107], a[16:19], a[44:47], v[104:107]
  ds_read_b64_tr_b16 a[24:25], v6 offset:43008
  v_mfma_f32_16x16x32_bf16 v[104:107], a[4:7], a[52:55], v[104:107]
  ds_read_b64_tr_b16 a[26:27], v6 offset:44544
  v_mfma_f32_16x16x32_bf16 v[92:95], a[28:31], a[52:55], v[92:95]
  ds_read_b64_tr_b16 a[28:29], v6 offset:43016
  v_mfma_f32_16x16x32_bf16 v[92:95], a[16:19], a[48:51], v[92:95]
  ds_read_b64_tr_b16 a[30:31], v6 offset:44552
  ds_read_b128 a[36:39], v0 offset:2048
  v_mfma_f32_16x16x32_bf16 v[92:95], a[4:7], a[40:43], v[92:95]
  ds_read_b64_tr_b16 a[16:17], v6 offset:39944
  v_mfma_f32_16x16x32_bf16 v[96:99], a[8:11], a[40:43], v[96:99]
  ds_read_b64_tr_b16 a[18:19], v6 offset:41480
  v_mfma_f32_16x16x32_bf16 v[96:99], a[20:23], a[48:51], v[96:99]
  ds_read_b64_tr_b16 a[4:5], v6 offset:36872
  v_mfma_f32_16x16x32_bf16 v[96:99], a[32:35], a[52:55], v[96:99]
  ds_read_b64_tr_b16 a[6:7], v6 offset:38408
  v_mfma_f32_16x16x32_bf16 v[108:111], a[8:11], a[52:55], v[108:111]
  ds_read_b64_tr_b16 a[8:9], v6 offset:36880
  v_mfma_f32_16x16x32_bf16 v[108:111], a[20:23], a[44:47], v[108:111]
  ds_read_b64_tr_b16 a[10:11], v6 offset:38416
  v_mfma_f32_16x16x32_bf16 v[108:111], a[32:35], a[56:59], v[108:111]
  s_waitcnt lgkmcnt(6)
  ds_read_b64_tr_b16 a[20:21], v6 offset:39952
  v_mfma_f32_16x16x32_bf16 v[28:31], a[0:3], v[12:15], v[28:31]
  ds_read_b64_tr_b16 a[22:23], v6 offset:41488
  v_mfma_f32_16x16x32_bf16 v[28:31], a[12:15], v[16:19], v[28:31]
  ds_read_b64_tr_b16 a[32:33], v6 offset:43024
  v_mfma_f32_16x16x32_bf16 v[28:31], a[24:27], v[20:23], v[28:31]
  ds_read_b64_tr_b16 a[34:35], v6 offset:44560
  v_mfma_f32_16x16x32_bf16 v[40:43], a[0:3], v[20:23], v[40:43]
  v_mfma_f32_16x16x32_bf16 v[40:43], a[12:15], v[24:27], v[40:43]
  ds_read_b128 a[40:43], v0 offset:2560
  v_mfma_f32_16x16x32_bf16 v[40:43], a[24:27], a[36:39], v[40:43]
  s_waitcnt lgkmcnt(7)
  v_mfma_f32_16x16x32_bf16 v[44:47], a[28:31], a[36:39], v[44:47]
  ds_read_b128 a[48:51], v0 offset:3072
  v_mfma_f32_16x16x32_bf16 v[44:47], a[16:19], v[24:27], v[44:47]
  v_mfma_f32_16x16x32_bf16 v[44:47], a[4:7], v[20:23], v[44:47]
  v_mfma_f32_16x16x32_bf16 v[32:35], a[28:31], v[20:23], v[32:35]
  v_mfma_f32_16x16x32_bf16 v[32:35], a[16:19], v[16:19], v[32:35]
  v_mfma_f32_16x16x32_bf16 v[32:35], a[4:7], v[12:15], v[32:35]
  s_waitcnt lgkmcnt(2)
  v_mfma_f32_16x16x32_bf16 v[36:39], a[8:11], v[12:15], v[36:39]
  v_mfma_f32_16x16x32_bf16 v[36:39], a[20:23], v[16:19], v[36:39]
  ds_read_b128 a[52:55], v0 offset:3584
  v_mfma_f32_16x16x32_bf16 v[36:39], a[32:35], v[20:23], v[36:39]
  ds_read_b128 a[44:47], v0 offset:4096
  v_mfma_f32_16x16x32_bf16 v[48:51], a[8:11], v[20:23], v[48:51]
  v_mfma_f32_16x16x32_bf16 v[48:51], a[20:23], v[24:27], v[48:51]
  v_mfma_f32_16x16x32_bf16 v[48:51], a[32:35], a[36:39], v[48:51]
  v_mfma_f32_16x16x32_bf16 v[52:55], a[0:3], a[36:39], v[52:55]
  s_waitcnt lgkmcnt(2)
  v_mfma_f32_16x16x32_bf16 v[52:55], a[12:15], a[40:43], v[52:55]
  v_mfma_f32_16x16x32_bf16 v[52:55], a[24:27], a[48:51], v[52:55]
  v_mfma_f32_16x16x32_bf16 v[56:59], a[28:31], a[48:51], v[56:59]
  v_mfma_f32_16x16x32_bf16 v[56:59], a[16:19], a[40:43], v[56:59]
  ds_read_b128 a[56:59], v0 offset:4608
  v_mfma_f32_16x16x32_bf16 v[56:59], a[4:7], a[36:39], v[56:59]
  ds_read_b128 v[12:15], v0 offset:5120
  v_mfma_f32_16x16x32_bf16 v[60:63], a[8:11], a[36:39], v[60:63]
  v_mfma_f32_16x16x32_bf16 v[60:63], a[20:23], a[40:43], v[60:63]
  v_mfma_f32_16x16x32_bf16 v[60:63], a[32:35], a[48:51], v[60:63]
  v_mfma_f32_16x16x32_bf16 v[64:67], a[0:3], a[48:51], v[64:67]
  s_waitcnt lgkmcnt(2)
  v_mfma_f32_16x16x32_bf16 v[64:67], a[12:15], a[52:55], v[64:67]
  v_mfma_f32_16x16x32_bf16 v[64:67], a[24:27], a[44:47], v[64:67]
  v_mfma_f32_16x16x32_bf16 v[68:71], a[28:31], a[44:47], v[68:71]
  v_mfma_f32_16x16x32_bf16 v[68:71], a[16:19], a[52:55], v[68:71]
  ds_read_b128 v[16:19], v0 offset:5632
  v_mfma_f32_16x16x32_bf16 v[68:71], a[4:7], a[48:51], v[68:71]
  ds_read_b128 v[20:23], v0 offset:6144
  v_mfma_f32_16x16x32_bf16 v[72:75], a[8:11], a[48:51], v[72:75]
  ds_read_b128 v[24:27], v0 offset:6656
  v_mfma_f32_16x16x32_bf16 v[72:75], a[20:23], a[52:55], v[72:75]
  ds_read_b128 a[36:39], v0 offset:7168
  v_mfma_f32_16x16x32_bf16 v[72:75], a[32:35], a[44:47], v[72:75]
  v_mfma_f32_16x16x32_bf16 v[76:79], a[0:3], a[44:47], v[76:79]
  s_waitcnt lgkmcnt(4)
  v_mfma_f32_16x16x32_bf16 v[76:79], a[12:15], a[56:59], v[76:79]
  v_mfma_f32_16x16x32_bf16 v[76:79], a[24:27], v[12:15], v[76:79]
  v_mfma_f32_16x16x32_bf16 v[80:83], a[28:31], v[12:15], v[80:83]
  v_mfma_f32_16x16x32_bf16 v[80:83], a[16:19], a[56:59], v[80:83]
  v_mfma_f32_16x16x32_bf16 v[80:83], a[4:7], a[44:47], v[80:83]
  v_mfma_f32_16x16x32_bf16 v[84:87], a[8:11], a[44:47], v[84:87]
  s_barrier
  v_mfma_f32_16x16x32_bf16 v[84:87], a[20:23], a[56:59], v[84:87]
  ds_read_b128 a[40:43], v0 offset:8256
  v_mfma_f32_16x16x32_bf16 v[84:87], a[32:35], v[12:15], v[84:87]
  ds_read_b128 a[48:51], v0 offset:8768
  v_mfma_f32_16x16x32_bf16 v[88:91], a[0:3], v[12:15], v[88:91]
  s_waitcnt lgkmcnt(2)
  v_mfma_f32_16x16x32_bf16 v[88:91], a[12:15], v[16:19], v[88:91]
  ds_read_b128 a[52:55], v0 offset:9280
  v_mfma_f32_16x16x32_bf16 v[88:91], a[24:27], v[20:23], v[88:91]
  ds_read_b128 a[44:47], v0 offset:9792
  v_mfma_f32_16x16x32_bf16 v[100:103], a[0:3], v[20:23], v[100:103]
  ds_read_b64_tr_b16 a[0:1], v6 offset:0
  v_mfma_f32_16x16x32_bf16 v[100:103], a[12:15], v[24:27], v[100:103]
  ds_read_b64_tr_b16 a[2:3], v6 offset:1536
  v_mfma_f32_16x16x32_bf16 v[100:103], a[24:27], a[36:39], v[100:103]
  ds_read_b64_tr_b16 a[12:13], v6 offset:3072
  v_mfma_f32_16x16x32_bf16 v[104:107], a[28:31], a[36:39], v[104:107]
  ds_read_b64_tr_b16 a[14:15], v6 offset:4608
  v_mfma_f32_16x16x32_bf16 v[104:107], a[16:19], v[24:27], v[104:107]
  ds_read_b64_tr_b16 a[24:25], v6 offset:6144
  v_mfma_f32_16x16x32_bf16 v[104:107], a[4:7], v[20:23], v[104:107]
  ds_read_b64_tr_b16 a[26:27], v6 offset:7680
  v_mfma_f32_16x16x32_bf16 v[92:95], a[28:31], v[20:23], v[92:95]
  ds_read_b64_tr_b16 a[28:29], v6 offset:6152
  v_mfma_f32_16x16x32_bf16 v[92:95], a[16:19], v[16:19], v[92:95]
  ds_read_b64_tr_b16 a[30:31], v6 offset:7688
  ds_read_b128 a[56:59], v0 offset:10304
  v_mfma_f32_16x16x32_bf16 v[92:95], a[4:7], v[12:15], v[92:95]
  ds_read_b64_tr_b16 a[16:17], v6 offset:3080
  v_mfma_f32_16x16x32_bf16 v[96:99], a[8:11], v[12:15], v[96:99]
  ds_read_b64_tr_b16 a[18:19], v6 offset:4616
  v_mfma_f32_16x16x32_bf16 v[96:99], a[20:23], v[16:19], v[96:99]
  ds_read_b64_tr_b16 a[4:5], v6 offset:8
  v_mfma_f32_16x16x32_bf16 v[96:99], a[32:35], v[20:23], v[96:99]
  ds_read_b64_tr_b16 a[6:7], v6 offset:1544
  v_mfma_f32_16x16x32_bf16 v[108:111], a[8:11], v[20:23], v[108:111]
  ds_read_b64_tr_b16 a[8:9], v6 offset:16
  v_mfma_f32_16x16x32_bf16 v[108:111], a[20:23], v[24:27], v[108:111]
  ds_read_b64_tr_b16 a[10:11], v6 offset:1552
  v_mfma_f32_16x16x32_bf16 v[108:111], a[32:35], a[36:39], v[108:111]
  s_waitcnt lgkmcnt(6)
  ds_read_b64_tr_b16 a[20:21], v6 offset:3088
  v_mfma_f32_16x16x32_bf16 v[28:31], a[0:3], a[40:43], v[28:31]
  ds_read_b64_tr_b16 a[22:23], v6 offset:4624
  v_mfma_f32_16x16x32_bf16 v[28:31], a[12:15], a[48:51], v[28:31]
  ds_read_b64_tr_b16 a[32:33], v6 offset:6160
  v_mfma_f32_16x16x32_bf16 v[28:31], a[24:27], a[52:55], v[28:31]
  ds_read_b64_tr_b16 a[34:35], v6 offset:7696
  v_mfma_f32_16x16x32_bf16 v[40:43], a[0:3], a[52:55], v[40:43]
  ds_read_b128 v[12:15], v0 offset:10816
  ds_read_b128 v[16:19], v0 offset:11328
  v_mfma_f32_16x16x32_bf16 v[40:43], a[12:15], a[44:47], v[40:43]
  ds_read_b128 v[20:23], v0 offset:11840
  ds_read_b128 v[24:27], v0 offset:12352
  v_mfma_f32_16x16x32_bf16 v[40:43], a[24:27], a[56:59], v[40:43]
  s_waitcnt lgkmcnt(10)
  v_mfma_f32_16x16x32_bf16 v[44:47], a[28:31], a[56:59], v[44:47]
  v_mfma_f32_16x16x32_bf16 v[44:47], a[16:19], a[44:47], v[44:47]
  v_mfma_f32_16x16x32_bf16 v[44:47], a[4:7], a[52:55], v[44:47]
  v_mfma_f32_16x16x32_bf16 v[32:35], a[28:31], a[52:55], v[32:35]
  s_barrier
  v_mfma_f32_16x16x32_bf16 v[32:35], a[16:19], a[48:51], v[32:35]
  v_mfma_f32_16x16x32_bf16 v[32:35], a[4:7], a[40:43], v[32:35]
  s_waitcnt lgkmcnt(4)
  v_mfma_f32_16x16x32_bf16 v[36:39], a[8:11], a[40:43], v[36:39]
  v_mfma_f32_16x16x32_bf16 v[36:39], a[20:23], a[48:51], v[36:39]
  v_mfma_f32_16x16x32_bf16 v[36:39], a[32:35], a[52:55], v[36:39]
  v_mfma_f32_16x16x32_bf16 v[48:51], a[8:11], a[52:55], v[48:51]
  v_mfma_f32_16x16x32_bf16 v[48:51], a[20:23], a[44:47], v[48:51]
  v_mfma_f32_16x16x32_bf16 v[48:51], a[32:35], a[56:59], v[48:51]
  v_mfma_f32_16x16x32_bf16 v[52:55], a[0:3], a[56:59], v[52:55]
  s_waitcnt lgkmcnt(2)
  v_mfma_f32_16x16x32_bf16 v[52:55], a[12:15], v[12:15], v[52:55]
  v_mfma_f32_16x16x32_bf16 v[52:55], a[24:27], v[16:19], v[52:55]
  v_mfma_f32_16x16x32_bf16 v[56:59], a[28:31], v[16:19], v[56:59]
  v_mfma_f32_16x16x32_bf16 v[56:59], a[16:19], v[12:15], v[56:59]
  ds_read_b128 a[36:39], v0 offset:12864
  v_mfma_f32_16x16x32_bf16 v[56:59], a[4:7], a[56:59], v[56:59]
  ds_read_b128 a[40:43], v0 offset:13376
  v_mfma_f32_16x16x32_bf16 v[60:63], a[8:11], a[56:59], v[60:63]
  v_mfma_f32_16x16x32_bf16 v[60:63], a[20:23], v[12:15], v[60:63]
  v_mfma_f32_16x16x32_bf16 v[60:63], a[32:35], v[16:19], v[60:63]
  v_mfma_f32_16x16x32_bf16 v[64:67], a[0:3], v[16:19], v[64:67]
  s_waitcnt lgkmcnt(2)
  v_mfma_f32_16x16x32_bf16 v[64:67], a[12:15], v[20:23], v[64:67]
  v_mfma_f32_16x16x32_bf16 v[64:67], a[24:27], v[24:27], v[64:67]
  v_mfma_f32_16x16x32_bf16 v[68:71], a[28:31], v[24:27], v[68:71]
  v_mfma_f32_16x16x32_bf16 v[68:71], a[16:19], v[20:23], v[68:71]
  ds_read_b128 a[48:51], v0 offset:13888
  v_mfma_f32_16x16x32_bf16 v[68:71], a[4:7], v[16:19], v[68:71]
  ds_read_b128 a[52:55], v0 offset:14400
  v_mfma_f32_16x16x32_bf16 v[72:75], a[8:11], v[16:19], v[72:75]
  ds_read_b128 a[44:47], v0 offset:14912
  v_mfma_f32_16x16x32_bf16 v[72:75], a[20:23], v[20:23], v[72:75]
  ds_read_b128 a[56:59], v0 offset:15424
  v_mfma_f32_16x16x32_bf16 v[72:75], a[32:35], v[24:27], v[72:75]
  v_mfma_f32_16x16x32_bf16 v[76:79], a[0:3], v[24:27], v[76:79]
  s_waitcnt lgkmcnt(4)
  v_mfma_f32_16x16x32_bf16 v[76:79], a[12:15], a[36:39], v[76:79]
  v_mfma_f32_16x16x32_bf16 v[76:79], a[24:27], a[40:43], v[76:79]
  v_mfma_f32_16x16x32_bf16 v[80:83], a[28:31], a[40:43], v[80:83]
  v_mfma_f32_16x16x32_bf16 v[80:83], a[16:19], a[36:39], v[80:83]
  v_mfma_f32_16x16x32_bf16 v[80:83], a[4:7], v[24:27], v[80:83]
  v_mfma_f32_16x16x32_bf16 v[84:87], a[8:11], v[24:27], v[84:87]
  s_barrier
  v_mfma_f32_16x16x32_bf16 v[84:87], a[20:23], a[36:39], v[84:87]
  ds_read_b128 v[12:15], v0 offset:16512
  v_mfma_f32_16x16x32_bf16 v[84:87], a[32:35], a[40:43], v[84:87]
  ds_read_b128 v[16:19], v0 offset:17024
L_pg1:
  s_cmp_lg_u32 s32, 0
  s_cbranch_scc1 L_pr1
  v_mfma_f32_16x16x32_bf16 v[88:91], a[0:3], a[40:43], v[88:91]
  s_waitcnt lgkmcnt(2)
  v_mfma_f32_16x16x32_bf16 v[88:91], a[12:15], a[48:51], v[88:91]
  ds_read_b128 v[20:23], v0 offset:17536
  v_mfma_f32_16x16x32_bf16 v[88:91], a[24:27], a[52:55], v[88:91]
  ds_read_b128 v[24:27], v0 offset:18048
  v_mfma_f32_16x16x32_bf16 v[100:103], a[0:3], a[52:55], v[100:103]
  ds_read_b64_tr_b16 a[0:1], v7 offset:0
  v_mfma_f32_16x16x32_bf16 v[100:103], a[12:15], a[44:47], v[100:103]
  ds_read_b64_tr_b16 a[2:3], v7 offset:1536
  v_mfma_f32_16x16x32_bf16 v[100:103], a[24:27], a[56:59], v[100:103]
  ds_read_b64_tr_b16 a[12:13], v7 offset:3072
  v_mfma_f32_16x16x32_bf16 v[104:107], a[28:31], a[56:59], v[104:107]
  ds_read_b64_tr_b16 a[14:15], v7 offset:4608
  v_mfma_f32_16x16x32_bf16 v[104:107], a[16:19], a[44:47], v[104:107]
  ds_read_b64_tr_b16 a[24:25], v7 offset:6144
  v_mfma_f32_16x16x32_bf16 v[104:107], a[4:7], a[52:55], v[104:107]
  ds_read_b64_tr_b16 a[26:27], v7 offset:7680
  v_mfma_f32_16x16x32_bf16 v[92:95], a[28:31], a[52:55], v[92:95]
  ds_read_b64_tr_b16 a[28:29], v7 offset:6152
  v_mfma_f32_16x16x32_bf16 v[92:95], a[16:19], a[48:51], v[92:95]
  ds_read_b64_tr_b16 a[30:31], v7 offset:7688
  ds_read_b128 a[36:39], v0 offset:18560
  v_mfma_f32_16x16x32_bf16 v[92:95], a[4:7], a[40:43], v[92:95]
  ds_read_b64_tr_b16 a[16:17], v7 offset:3080
  v_mfma_f32_16x16x32_bf16 v[96:99], a[8:11], a[40:43], v[96:99]
  ds_read_b64_tr_b16 a[18:19], v7 offset:4616
  v_mfma_f32_16x16x32_bf16 v[96:99], a[20:23], a[48:51], v[96:99]
  ds_read_b64_tr_b16 a[4:5], v7 offset:8
  v_mfma_f32_16x16x32_bf16 v[96:99], a[32:35], a[52:55], v[96:99]
  ds_read_b64_tr_b16 a[6:7], v7 offset:1544
  v_mfma_f32_16x16x32_bf16 v[108:111], a[8:11], a[52:55], v[108:111]
  ds_read_b64_tr_b16 a[8:9], v7 offset:16
  v_mfma_f32_16x16x32_bf16 v[108:111], a[20:23], a[44:47], v[108:111]
  ds_read_b64_tr_b16 a[10:11], v7 offset:1552
  v_mfma_f32_16x16x32_bf16 v[108:111], a[32:35], a[56:59], v[108:111]
  s_waitcnt lgkmcnt(6)
  ds_read_b64_tr_b16 a[20:21], v7 offset:3088
  v_mfma_f32_16x16x32_bf16 v[112:115], a[0:3], v[12:15], v[28:31]
  ds_read_b64_tr_b16 a[22:23], v7 offset:4624
  v_mfma_f32_16x16x32_bf16 v[112:115], a[12:15], v[16:19], v[112:115]
  ds_read_b64_tr_b16 a[32:33], v7 offset:6160
  v_mfma_f32_16x16x32_bf16 v[112:115], a[24:27], v[20:23], v[112:115]
  ds_read_b64_tr_b16 a[34:35], v7 offset:7696
  v_mfma_f32_16x16x32_bf16 v[124:127], a[0:3], v[20:23], v[40:43]
  v_mfma_f32_16x16x32_bf16 v[124:127], a[12:15], v[24:27], v[124:127]
  ds_read_b128 a[40:43], v0 offset:19072
  v_mfma_f32_16x16x32_bf16 v[124:127], a[24:27], a[36:39], v[124:127]
  s_waitcnt lgkmcnt(7)
  v_mfma_f32_16x16x32_bf16 v[128:131], a[28:31], a[36:39], v[44:47]
  ds_read_b128 a[48:51], v0 offset:19584
  v_mfma_f32_16x16x32_bf16 v[128:131], a[16:19], v[24:27], v[128:131]
  v_mfma_f32_16x16x32_bf16 v[128:131], a[4:7], v[20:23], v[128:131]
  v_mfma_f32_16x16x32_bf16 v[116:119], a[28:31], v[20:23], v[32:35]
  v_mfma_f32_16x16x32_bf16 v[116:119], a[16:19], v[16:19], v[116:119]
  v_mfma_f32_16x16x32_bf16 v[116:119], a[4:7], v[12:15], v[116:119]
  s_waitcnt lgkmcnt(2)
  v_mfma_f32_16x16x32_bf16 v[120:123], a[8:11], v[12:15], v[36:39]
  v_mfma_f32_16x16x32_bf16 v[120:123], a[20:23], v[16:19], v[120:123]
  ds_read_b128 a[52:55], v0 offset:20096
  v_mfma_f32_16x16x32_bf16 v[120:123], a[32:35], v[20:23], v[120:123]
  ds_read_b128 a[44:47], v0 offset:20608
  v_mfma_f32_16x16x32_bf16 v[132:135], a[8:11], v[20:23], v[48:51]
  v_mfma_f32_16x16x32_bf16 v[132:135], a[20:23], v[24:27], v[132:135]
  v_mfma_f32_16x16x32_bf16 v[132:135], a[32:35], a[36:39], v[132:135]
  v_mfma_f32_16x16x32_bf16 v[136:139], a[0:3], a[36:39], v[52:55]
  s_waitcnt lgkmcnt(2)
  v_mfma_f32_16x16x32_bf16 v[136:139], a[12:15], a[40:43], v[136:139]
  v_mfma_f32_16x16x32_bf16 v[136:139], a[24:27], a[48:51], v[136:139]
  v_mfma_f32_16x16x32_bf16 v[140:143], a[28:31], a[48:51], v[56:59]
  v_mfma_f32_16x16x32_bf16 v[140:143], a[16:19], a[40:43], v[140:143]
  ds_read_b128 a[56:59], v0 offset:21120
  v_mfma_f32_16x16x32_bf16 v[140:143], a[4:7], a[36:39], v[140:143]
  ds_read_b128 v[12:15], v0 offset:21632
  v_mfma_f32_16x16x32_bf16 v[144:147], a[8:11], a[36:39], v[60:63]
  v_mfma_f32_16x16x32_bf16 v[144:147], a[20:23], a[40:43], v[144:147]
  v_mfma_f32_16x16x32_bf16 v[144:147], a[32:35], a[48:51], v[144:147]
  v_mfma_f32_16x16x32_bf16 v[148:151], a[0:3], a[48:51], v[64:67]
  s_waitcnt lgkmcnt(2)
  v_mfma_f32_16x16x32_bf16 v[148:151], a[12:15], a[52:55], v[148:151]
  v_mfma_f32_16x16x32_bf16 v[148:151], a[24:27], a[44:47], v[148:151]
  v_mfma_f32_16x16x32_bf16 v[152:155], a[28:31], a[44:47], v[68:71]
  v_mfma_f32_16x16x32_bf16 v[152:155], a[16:19], a[52:55], v[152:155]
  ds_read_b128 v[16:19], v0 offset:22144
  v_mfma_f32_16x16x32_bf16 v[152:155], a[4:7], a[48:51], v[152:155]
  ds_read_b128 v[20:23], v0 offset:22656
  v_mfma_f32_16x16x32_bf16 v[156:159], a[8:11], a[48:51], v[72:75]
  ds_read_b128 v[24:27], v0 offset:23168
  v_mfma_f32_16x16x32_bf16 v[156:159], a[20:23], a[52:55], v[156:159]
  ds_read_b128 a[36:39], v0 offset:23680
  v_mfma_f32_16x16x32_bf16 v[156:159], a[32:35], a[44:47], v[156:159]
  v_mfma_f32_16x16x32_bf16 v[160:163], a[0:3], a[44:47], v[76:79]
  s_waitcnt lgkmcnt(4)
  v_mfma_f32_16x16x32_bf16 v[160:163], a[12:15], a[56:59], v[160:163]
  v_mfma_f32_16x16x32_bf16 v[160:163], a[24:27], v[12:15], v[160:163]
  v_mfma_f32_16x16x32_bf16 v[164:167], a[28:31], v[12:15], v[80:83]
  v_mfma_f32_16x16x32_bf16 v[164:167], a[16:19], a[56:59], v[164:167]
  v_mfma_f32_16x16x32_bf16 v[164:167], a[4:7], a[44:47], v[164:167]
  v_mfma_f32_16x16x32_bf16 v[168:171], a[8:11], a[44:47], v[84:87]
  s_barrier
  v_mfma_f32_16x16x32_bf16 v[168:171], a[20:23], a[56:59], v[168:171]
  ds_read_b128 a[40:43], v0 offset:24768
  v_mfma_f32_16x16x32_bf16 v[168:171], a[32:35], v[12:15], v[168:171]
  ds_read_b128 a[48:51], v0 offset:25280
  v_mfma_f32_16x16x32_bf16 v[172:175], a[0:3], v[12:15], v[88:91]
  s_waitcnt lgkmcnt(2)
  v_mfma_f32_16x16x32_bf16 v[172:175], a[12:15], v[16:19], v[172:175]
  ds_read_b128 a[52:55], v0 offset:25792
  v_mfma_f32_16x16x32_bf16 v[172:175], a[24:27], v[20:23], v[172:175]
  ds_read_b128 a[44:47], v0 offset:26304
  v_mfma_f32_16x16x32_bf16 v[184:187], a[0:3], v[20:23], v[100:103]
  ds_read_b64_tr_b16 a[0:1], v6 offset:36864
  v_mfma_f32_16x16x32_bf16 v[184:187], a[12:15], v[24:27], v[184:187]
  ds_read_b64_tr_b16 a[2:3], v6 offset:38400
  v_mfma_f32_16x16x32_bf16 v[184:187], a[24:27], a[36:39], v[184:187]
  ds_read_b64_tr_b16 a[12:13], v6 offset:39936
  v_mfma_f32_16x16x32_bf16 v[188:191], a[28:31], a[36:39], v[104:107]
  ds_read_b64_tr_b16 a[14:15], v6 offset:41472
  v_mfma_f32_16x16x32_bf16 v[188:191], a[16:19], v[24:27], v[188:191]
  ds_read_b64_tr_b16 a[24:25], v6 offset:43008
  v_mfma_f32_16x16x32_bf16 v[188:191], a[4:7], v[20:23], v[188:191]
  ds_read_b64_tr_b16 a[26:27], v6 offset:44544
  v_mfma_f32_16x16x32_bf16 v[176:179], a[28:31], v[20:23], v[92:95]
  ds_read_b64_tr_b16 a[28:29], v6 offset:43016
  v_mfma_f32_16x16x32_bf16 v[176:179], a[16:19], v[16:19], v[176:179]
  ds_read_b64_tr_b16 a[30:31], v6 offset:44552
  ds_read_b128 a[56:59], v0 offset:26816
  v_mfma_f32_16x16x32_bf16 v[176:179], a[4:7], v[12:15], v[176:179]
  ds_read_b64_tr_b16 a[16:17], v6 offset:39944
  v_mfma_f32_16x16x32_bf16 v[180:183], a[8:11], v[12:15], v[96:99]
  ds_read_b64_tr_b16 a[18:19], v6 offset:41480
  v_mfma_f32_16x16x32_bf16 v[180:183], a[20:23], v[16:19], v[180:183]
  ds_read_b64_tr_b16 a[4:5], v6 offset:36872
  v_mfma_f32_16x16x32_bf16 v[180:183], a[32:35], v[20:23], v[180:183]
  ds_read_b64_tr_b16 a[6:7], v6 offset:38408
  v_mfma_f32_16x16x32_bf16 v[192:195], a[8:11], v[20:23], v[108:111]
  ds_read_b64_tr_b16 a[8:9], v6 offset:36880
  v_mfma_f32_16x16x32_bf16 v[192:195], a[20:23], v[24:27], v[192:195]
  ds_read_b64_tr_b16 a[10:11], v6 offset:38416
  v_mfma_f32_16x16x32_bf16 v[192:195], a[32:35], a[36:39], v[192:195]
  s_waitcnt lgkmcnt(6)
  ds_read_b64_tr_b16 a[20:21], v6 offset:39952
  v_mfma_f32_16x16x32_bf16 v[112:115], a[0:3], a[40:43], v[112:115]
  ds_read_b64_tr_b16 a[22:23], v6 offset:41488
  v_mfma_f32_16x16x32_bf16 v[112:115], a[12:15], a[48:51], v[112:115]
  ds_read_b64_tr_b16 a[32:33], v6 offset:43024
  v_mfma_f32_16x16x32_bf16 v[112:115], a[24:27], a[52:55], v[112:115]
  ds_read_b64_tr_b16 a[34:35], v6 offset:44560
  v_mfma_f32_16x16x32_bf16 v[124:127], a[0:3], a[52:55], v[124:127]
  ds_read_b128 v[12:15], v0 offset:27328
  ds_read_b128 v[16:19], v0 offset:27840
  v_mfma_f32_16x16x32_bf16 v[124:127], a[12:15], a[44:47], v[124:127]
  ds_read_b128 v[20:23], v0 offset:28352
  ds_read_b128 v[24:27], v0 offset:28864
  v_mfma_f32_16x16x32_bf16 v[124:127], a[24:27], a[56:59], v[124:127]
  s_waitcnt lgkmcnt(10)
  v_mfma_f32_16x16x32_bf16 v[128:131], a[28:31], a[56:59], v[128:131]
  v_mfma_f32_16x16x32_bf16 v[128:131], a[16:19], a[44:47], v[128:131]
  v_mfma_f32_16x16x32_bf16 v[128:131], a[4:7], a[52:55], v[128:131]
  v_mfma_f32_16x16x32_bf16 v[116:119], a[28:31], a[52:55], v[116:119]
  s_barrier
  v_mfma_f32_16x16x32_bf16 v[116:119], a[16:19], a[48:51], v[116:119]
  v_mfma_f32_16x16x32_bf16 v[116:119], a[4:7], a[40:43], v[116:119]
  s_waitcnt lgkmcnt(4)
  v_mfma_f32_16x16x32_bf16 v[120:123], a[8:11], a[40:43], v[120:123]
  v_mfma_f32_16x16x32_bf16 v[120:123], a[20:23], a[48:51], v[120:123]
  v_mfma_f32_16x16x32_bf16 v[120:123], a[32:35], a[52:55], v[120:123]
  v_mfma_f32_16x16x32_bf16 v[132:135], a[8:11], a[52:55], v[132:135]
  v_mfma_f32_16x16x32_bf16 v[132:135], a[20:23], a[44:47], v[132:135]
  v_mfma_f32_16x16x32_bf16 v[132:135], a[32:35], a[56:59], v[132:135]
  v_mfma_f32_16x16x32_bf16 v[136:139], a[0:3], a[56:59], v[136:139]
  s_waitcnt lgkmcnt(2)
  v_mfma_f32_16x16x32_bf16 v[136:139], a[12:15], v[12:15], v[136:139]
  v_mfma_f32_16x16x32_bf16 v[136:139], a[24:27], v[16:19], v[136:139]
  v_mfma_f32_16x16x32_bf16 v[140:143], a[28:31], v[16:19], v[140:143]
  v_mfma_f32_16x16x32_bf16 v[140:143], a[16:19], v[12:15], v[140:143]
  ds_read_b128 a[36:39], v0 offset:29376
  v_mfma_f32_16x16x32_bf16 v[140:143], a[4:7], a[56:59], v[140:143]
  ds_read_b128 a[40:43], v0 offset:29888
  v_mfma_f32_16x16x32_bf16 v[144:147], a[8:11], a[56:59], v[144:147]
  v_mfma_f32_16x16x32_bf16 v[144:147], a[20:23], v[12:15], v[144:147]
  v_mfma_f32_16x16x32_bf16 v[144:147], a[32:35], v[16:19], v[144:147]
  v_mfma_f32_16x16x32_bf16 v[148:151], a[0:3], v[16:19], v[148:151]
  s_waitcnt lgkmcnt(2)
  v_mfma_f32_16x16x32_bf16 v[148:151], a[12:15], v[20:23], v[148:151]
  v_mfma_f32_16x16x32_bf16 v[148:151], a[24:27], v[24:27], v[148:151]
  v_mfma_f32_16x16x32_bf16 v[152:155], a[28:31], v[24:27], v[152:155]
  v_mfma_f32_16x16x32_bf16 v[152:155], a[16:19], v[20:23], v[152:155]
  ds_read_b128 a[48:51], v0 offset:30400
  v_mfma_f32_16x16x32_bf16 v[152:155], a[4:7], v[16:19], v[152:155]
  ds_read_b128 a[52:55], v0 offset:30912
  v_mfma_f32_16x16x32_bf16 v[156:159], a[8:11], v[16:19], v[156:159]
  ds_read_b128 a[44:47], v0 offset:31424
  v_mfma_f32_16x16x32_bf16 v[156:159], a[20:23], v[20:23], v[156:159]
  ds_read_b128 a[56:59], v0 offset:31936
  v_mfma_f32_16x16x32_bf16 v[156:159], a[32:35], v[24:27], v[156:159]
  v_mfma_f32_16x16x32_bf16 v[160:163], a[0:3], v[24:27], v[160:163]
  s_waitcnt lgkmcnt(4)
  v_mfma_f32_16x16x32_bf16 v[160:163], a[12:15], a[36:39], v[160:163]
  v_mfma_f32_16x16x32_bf16 v[160:163], a[24:27], a[40:43], v[160:163]
  v_mfma_f32_16x16x32_bf16 v[164:167], a[28:31], a[40:43], v[164:167]
  v_mfma_f32_16x16x32_bf16 v[164:167], a[16:19], a[36:39], v[164:167]
  v_mfma_f32_16x16x32_bf16 v[164:167], a[4:7], v[24:27], v[164:167]
  v_mfma_f32_16x16x32_bf16 v[168:171], a[8:11], v[24:27], v[168:171]
  s_barrier
  v_mfma_f32_16x16x32_bf16 v[168:171], a[20:23], a[36:39], v[168:171]
  ds_read_b128 v[12:15], v0 offset:0
  v_mfma_f32_16x16x32_bf16 v[168:171], a[32:35], a[40:43], v[168:171]
  ds_read_b128 v[16:19], v0 offset:512
  v_mfma_f32_16x16x32_bf16 v[172:175], a[0:3], a[40:43], v[172:175]
  s_waitcnt lgkmcnt(2)
  v_mfma_f32_16x16x32_bf16 v[172:175], a[12:15], a[48:51], v[172:175]
  ds_read_b128 v[20:23], v0 offset:1024
  v_mfma_f32_16x16x32_bf16 v[172:175], a[24:27], a[52:55], v[172:175]
  ds_read_b128 v[24:27], v0 offset:1536
  v_mfma_f32_16x16x32_bf16 v[184:187], a[0:3], a[52:55], v[184:187]
  ds_read_b64_tr_b16 a[0:1], v6 offset:0
  v_mfma_f32_16x16x32_bf16 v[184:187], a[12:15], a[44:47], v[184:187]
  ds_read_b64_tr_b16 a[2:3], v6 offset:1536
  v_mfma_f32_16x16x32_bf16 v[184:187], a[24:27], a[56:59], v[184:187]
  ds_read_b64_tr_b16 a[12:13], v6 offset:3072
  v_mfma_f32_16x16x32_bf16 v[188:191], a[28:31], a[56:59], v[188:191]
  ds_read_b64_tr_b16 a[14:15], v6 offset:4608
  v_mfma_f32_16x16x32_bf16 v[188:191], a[16:19], a[44:47], v[188:191]
  ds_read_b64_tr_b16 a[24:25], v6 offset:6144
  v_mfma_f32_16x16x32_bf16 v[188:191], a[4:7], a[52:55], v[188:191]
  ds_read_b64_tr_b16 a[26:27], v6 offset:7680
  v_mfma_f32_16x16x32_bf16 v[176:179], a[28:31], a[52:55], v[176:179]
  ds_read_b64_tr_b16 a[28:29], v6 offset:6152
  v_mfma_f32_16x16x32_bf16 v[176:179], a[16:19], a[48:51], v[176:179]
  ds_read_b64_tr_b16 a[30:31], v6 offset:7688
  ds_read_b128 a[36:39], v0 offset:2048
  v_mfma_f32_16x16x32_bf16 v[176:179], a[4:7], a[40:43], v[176:179]
  ds_read_b64_tr_b16 a[16:17], v6 offset:3080
  v_mfma_f32_16x16x32_bf16 v[180:183], a[8:11], a[40:43], v[180:183]
  ds_read_b64_tr_b16 a[18:19], v6 offset:4616
  v_mfma_f32_16x16x32_bf16 v[180:183], a[20:23], a[48:51], v[180:183]
  ds_read_b64_tr_b16 a[4:5], v6 offset:8
  v_mfma_f32_16x16x32_bf16 v[180:183], a[32:35], a[52:55], v[180:183]
  ds_read_b64_tr_b16 a[6:7], v6 offset:1544
  v_mfma_f32_16x16x32_bf16 v[192:195], a[8:11], a[52:55], v[192:195]
  ds_read_b64_tr_b16 a[8:9], v6 offset:16
  v_mfma_f32_16x16x32_bf16 v[192:195], a[20:23], a[44:47], v[192:195]
  ds_read_b64_tr_b16 a[10:11], v6 offset:1552
  v_mfma_f32_16x16x32_bf16 v[192:195], a[32:35], a[56:59], v[192:195]
  s_waitcnt lgkmcnt(6)
  ds_read_b64_tr_b16 a[20:21], v6 offset:3088
  v_mfma_f32_16x16x32_bf16 v[28:31], a[0:3], v[12:15], v[28:31]
  ds_read_b64_tr_b16 a[22:23], v6 offset:4624
  v_mfma_f32_16x16x32_bf16 v[28:31], a[12:15], v[16:19], v[28:31]
  ds_read_b64_tr_b16 a[32:33], v6 offset:6160
  v_mfma_f32_16x16x32_bf16 v[28:31], a[24:27], v[20:23], v[28:31]
  ds_read_b64_tr_b16 a[34:35], v6 offset:7696
  v_mfma_f32_16x16x32_bf16 v[40:43], a[0:3], v[20:23], v[40:43]
  v_mfma_f32_16x16x32_bf16 v[40:43], a[12:15], v[24:27], v[40:43]
  ds_read_b128 a[40:43], v0 offset:2560
  v_mfma_f32_16x16x32_bf16 v[40:43], a[24:27], a[36:39], v[40:43]
  s_waitcnt lgkmcnt(7)
  v_mfma_f32_16x16x32_bf16 v[44:47], a[28:31], a[36:39], v[44:47]
  ds_read_b128 a[48:51], v0 offset:3072
  v_mfma_f32_16x16x32_bf16 v[44:47], a[16:19], v[24:27], v[44:47]
  v_mfma_f32_16x16x32_bf16 v[44:47], a[4:7], v[20:23], v[44:47]
  v_mfma_f32_16x16x32_bf16 v[32:35], a[28:31], v[20:23], v[32:35]
  v_mfma_f32_16x16x32_bf16 v[32:35], a[16:19], v[16:19], v[32:35]
  v_mfma_f32_16x16x32_bf16 v[32:35], a[4:7], v[12:15], v[32:35]
  s_waitcnt lgkmcnt(2)
  v_mfma_f32_16x16x32_bf16 v[36:39], a[8:11], v[12:15], v[36:39]
  v_mfma_f32_16x16x32_bf16 v[36:39], a[20:23], v[16:19], v[36:39]
  ds_read_b128 a[52:55], v0 offset:3584
  v_mfma_f32_16x16x32_bf16 v[36:39], a[32:35], v[20:23], v[36:39]
  ds_read_b128 a[44:47], v0 offset:4096
  v_mfma_f32_16x16x32_bf16 v[48:51], a[8:11], v[20:23], v[48:51]
  v_mfma_f32_16x16x32_bf16 v[48:51], a[20:23], v[24:27], v[48:51]
  v_mfma_f32_16x16x32_bf16 v[48:51], a[32:35], a[36:39], v[48:51]
  v_mfma_f32_16x16x32_bf16 v[52:55], a[0:3], a[36:39], v[52:55]
  s_waitcnt lgkmcnt(2)
  v_mfma_f32_16x16x32_bf16 v[52:55], a[12:15], a[40:43], v[52:55]
  v_mfma_f32_16x16x32_bf16 v[52:55], a[24:27], a[48:51], v[52:55]
  v_mfma_f32_16x16x32_bf16 v[56:59], a[28:31], a[48:51], v[56:59]
  v_mfma_f32_16x16x32_bf16 v[56:59], a[16:19], a[40:43], v[56:59]
  ds_read_b128 a[56:59], v0 offset:4608
  v_mfma_f32_16x16x32_bf16 v[56:59], a[4:7], a[36:39], v[56:59]
  ds_read_b128 v[12:15], v0 offset:5120
  v_mfma_f32_16x16x32_bf16 v[60:63], a[8:11], a[36:39], v[60:63]
  v_mfma_f32_16x16x32_bf16 v[60:63], a[20:23], a[40:43], v[60:63]
  v_mfma_f32_16x16x32_bf16 v[60:63], a[32:35], a[48:51], v[60:63]
  v_mfma_f32_16x16x32_bf16 v[64:67], a[0:3], a[48:51], v[64:67]
  s_waitcnt lgkmcnt(2)
  v_mfma_f32_16x16x32_bf16 v[64:67], a[12:15], a[52:55], v[64:67]
  v_mfma_f32_16x16x32_bf16 v[64:67], a[24:27], a[44:47], v[64:67]
  v_mfma_f32_16x16x32_bf16 v[68:71], a[28:31], a[44:47], v[68:71]
  v_mfma_f32_16x16x32_bf16 v[68:71], a[16:19], a[52:55], v[68:71]
  ds_read_b128 v[16:19], v0 offset:5632
  v_mfma_f32_16x16x32_bf16 v[68:71], a[4:7], a[48:51], v[68:71]
  ds_read_b128 v[20:23], v0 offset:6144
  v_mfma_f32_16x16x32_bf16 v[72:75], a[8:11], a[48:51], v[72:75]
  ds_read_b128 v[24:27], v0 offset:6656
  v_mfma_f32_16x16x32_bf16 v[72:75], a[20:23], a[52:55], v[72:75]
  ds_read_b128 a[36:39], v0 offset:7168
  v_mfma_f32_16x16x32_bf16 v[72:75], a[32:35], a[44:47], v[72:75]
  v_mfma_f32_16x16x32_bf16 v[76:79], a[0:3], a[44:47], v[76:79]
  s_waitcnt lgkmcnt(4)
  v_mfma_f32_16x16x32_bf16 v[76:79], a[12:15], a[56:59], v[76:79]
  v_mfma_f32_16x16x32_bf16 v[76:79], a[24:27], v[12:15], v[76:79]
  v_mfma_f32_16x16x32_bf16 v[80:83], a[28:31], v[12:15], v[80:83]
  v_mfma_f32_16x16x32_bf16 v[80:83], a[16:19], a[56:59], v[80:83]
  v_mfma_f32_16x16x32_bf16 v[80:83], a[4:7], a[44:47], v[80:83]
  v_mfma_f32_16x16x32_bf16 v[84:87], a[8:11], a[44:47], v[84:87]
  s_barrier
  v_mfma_f32_16x16x32_bf16 v[84:87], a[20:23], a[56:59], v[84:87]
  ds_read_b128 a[40:43], v0 offset:8256
  v_mfma_f32_16x16x32_bf16 v[84:87], a[32:35], v[12:15], v[84:87]
  ds_read_b128 a[48:51], v0 offset:8768
  v_mfma_f32_16x16x32_bf16 v[88:91], a[0:3], v[12:15], v[88:91]
  s_waitcnt lgkmcnt(2)
  v_mfma_f32_16x16x32_bf16 v[88:91], a[12:15], v[16:19], v[88:91]
  ds_read_b128 a[52:55], v0 offset:9280
  v_mfma_f32_16x16x32_bf16 v[88:91], a[24:27], v[20:23], v[88:91]
  ds_read_b128 a[44:47], v0 offset:9792
  v_mfma_f32_16x16x32_bf16 v[100:103], a[0:3], v[20:23], v[100:103]
  ds_read_b64_tr_b16 a[0:1], v7 offset:0
  v_mfma_f32_16x16x32_bf16 v[100:103], a[12:15], v[24:27], v[100:103]
  ds_read_b64_tr_b16 a[2:3], v7 offset:1536
  v_mfma_f32_16x16x32_bf16 v[100:103], a[24:27], a[36:39], v[100:103]
  ds_read_b64_tr_b16 a[12:13], v7 offset:3072
  v_mfma_f32_16x16x32_bf16 v[104:107], a[28:31], a[36:39], v[104:107]
  ds_read_b64_tr_b16 a[14:15], v7 offset:4608
  v_mfma_f32_16x16x32_bf16 v[104:107], a[16:19], v[24:27], v[104:107]
  ds_read_b64_tr_b16 a[24:25], v7 offset:6144
  v_mfma_f32_16x16x32_bf16 v[104:107], a[4:7], v[20:23], v[104:107]
  ds_read_b64_tr_b16 a[26:27], v7 offset:7680
  v_mfma_f32_16x16x32_bf16 v[92:95], a[28:31], v[20:23], v[92:95]
  ds_read_b64_tr_b16 a[28:29], v7 offset:6152
  v_mfma_f32_16x16x32_bf16 v[92:95], a[16:19], v[16:19], v[92:95]
  ds_read_b64_tr_b16 a[30:31], v7 offset:7688
  ds_read_b128 a[56:59], v0 offset:10304
  v_mfma_f32_16x16x32_bf16 v[92:95], a[4:7], v[12:15], v[92:95]
  ds_read_b64_tr_b16 a[16:17], v7 offset:3080
  v_mfma_f32_16x16x32_bf16 v[96:99], a[8:11], v[12:15], v[96:99]
  ds_read_b64_tr_b16 a[18:19], v7 offset:4616
  v_mfma_f32_16x16x32_bf16 v[96:99], a[20:23], v[16:19], v[96:99]
  ds_read_b64_tr_b16 a[4:5], v7 offset:8
  v_mfma_f32_16x16x32_bf16 v[96:99], a[32:35], v[20:23], v[96:99]
  ds_read_b64_tr_b16 a[6:7], v7 offset:1544
  v_mfma_f32_16x16x32_bf16 v[108:111], a[8:11], v[20:23], v[108:111]
  ds_read_b64_tr_b16 a[8:9], v7 offset:16
  v_mfma_f32_16x16x32_bf16 v[108:111], a[20:23], v[24:27], v[108:111]
  ds_read_b64_tr_b16 a[10:11], v7 offset:1552
  v_mfma_f32_16x16x32_bf16 v[108:111], a[32:35], a[36:39], v[108:111]
  s_waitcnt lgkmcnt(6)
  ds_read_b64_tr_b16 a[20:21], v7 offset:3088
  v_mfma_f32_16x16x32_bf16 v[28:31], a[0:3], a[40:43], v[28:31]
  ds_read_b64_tr_b16 a[22:23], v7 offset:4624
  v_mfma_f32_16x16x32_bf16 v[28:31], a[12:15], a[48:51], v[28:31]
  ds_read_b64_tr_b16 a[32:33], v7 offset:6160
  v_mfma_f32_16x16x32_bf16 v[28:31], a[24:27], a[52:55], v[28:31]
  ds_read_b64_tr_b16 a[34:35], v7 offset:7696
  v_mfma_f32_16x16x32_bf16 v[40:43], a[0:3], a[52:55], v[40:43]
  ds_read_b128 v[12:15], v0 offset:10816
  ds_read_b128 v[16:19], v0 offset:11328
  v_mfma_f32_16x16x32_bf16 v[40:43], a[12:15], a[44:47], v[40:43]
  ds_read_b128 v[20:23], v0 offset:11840
  ds_read_b128 v[24:27], v0 offset:12352
  v_mfma_f32_16x16x32_bf16 v[40:43], a[24:27], a[56:59], v[40:43]
  s_waitcnt lgkmcnt(10)
  v_mfma_f32_16x16x32_bf16 v[44:47], a[28:31], a[56:59], v[44:47]
  v_mfma_f32_16x16x32_bf16 v[44:47], a[16:19], a[44:47], v[44:47]
  v_mfma_f32_16x16x32_bf16 v[44:47], a[4:7], a[52:55], v[44:47]
  v_mfma_f32_16x16x32_bf16 v[32:35], a[28:31], a[52:55], v[32:35]
  s_barrier
  v_mfma_f32_16x16x32_bf16 v[32:35], a[16:19], a[48:51], v[32:35]
  v_mfma_f32_16x16x32_bf16 v[32:35], a[4:7], a[40:43], v[32:35]
  s_waitcnt lgkmcnt(4)
  v_mfma_f32_16x16x32_bf16 v[36:39], a[8:11], a[40:43], v[36:39]
  v_mfma_f32_16x16x32_bf16 v[36:39], a[20:23], a[48:51], v[36:39]
  v_mfma_f32_16x16x32_bf16 v[36:39], a[32:35], a[52:55], v[36:39]
  v_mfma_f32_16x16x32_bf16 v[48:51], a[8:11], a[52:55], v[48:51]
  v_mfma_f32_16x16x32_bf16 v[48:51], a[20:23], a[44:47], v[48:51]
  v_mfma_f32_16x16x32_bf16 v[48:51], a[32:35], a[56:59], v[48:51]
  v_mfma_f32_16x16x32_bf16 v[52:55], a[0:3], a[56:59], v[52:55]
  s_waitcnt lgkmcnt(2)
  v_mfma_f32_16x16x32_bf16 v[52:55], a[12:15], v[12:15], v[52:55]
  buffer_load_dwordx4 v[2:5], v1, s[24:27], 0 offen
  v_mfma_f32_16x16x32_bf16 v[52:55], a[24:27], v[16:19], v[52:55]
  v_mfma_f32_16x16x32_bf16 v[56:59], a[28:31], v[16:19], v[56:59]
  v_mfma_f32_16x16x32_bf16 v[56:59], a[16:19], v[12:15], v[56:59]
  ds_read_b128 a[36:39], v0 offset:12864
  v_mfma_f32_16x16x32_bf16 v[56:59], a[4:7], a[56:59], v[56:59]
  ds_read_b128 a[40:43], v0 offset:13376
  v_mfma_f32_16x16x32_bf16 v[60:63], a[8:11], a[56:59], v[60:63]
  v_mfma_f32_16x16x32_bf16 v[60:63], a[20:23], v[12:15], v[60:63]
  v_mfma_f32_16x16x32_bf16 v[60:63], a[32:35], v[16:19], v[60:63]
  v_mfma_f32_16x16x32_bf16 v[64:67], a[0:3], v[16:19], v[64:67]
  s_waitcnt lgkmcnt(2)
  v_mfma_f32_16x16x32_bf16 v[64:67], a[12:15], v[20:23], v[64:67]
  v_mfma_f32_16x16x32_bf16 v[64:67], a[24:27], v[24:27], v[64:67]
  buffer_load_dwordx2 v[10:11], v1, s[24:27], 0 offen offset:16
  v_mfma_f32_16x16x32_bf16 v[68:71], a[28:31], v[24:27], v[68:71]
  v_mfma_f32_16x16x32_bf16 v[68:71], a[16:19], v[20:23], v[68:71]
  ds_read_b128 a[48:51], v0 offset:13888
  v_mfma_f32_16x16x32_bf16 v[68:71], a[4:7], v[16:19], v[68:71]
  ds_read_b128 a[52:55], v0 offset:14400
  v_mfma_f32_16x16x32_bf16 v[72:75], a[8:11], v[16:19], v[72:75]
  ds_read_b128 a[44:47], v0 offset:14912
  v_mfma_f32_16x16x32_bf16 v[72:75], a[20:23], v[20:23], v[72:75]
  ds_read_b128 a[56:59], v0 offset:15424
  v_mfma_f32_16x16x32_bf16 v[72:75], a[32:35], v[24:27], v[72:75]
  v_mfma_f32_16x16x32_bf16 v[76:79], a[0:3], v[24:27], v[76:79]
  s_waitcnt lgkmcnt(4)
  v_mfma_f32_16x16x32_bf16 v[76:79], a[12:15], a[36:39], v[76:79]
  v_mfma_f32_16x16x32_bf16 v[76:79], a[24:27], a[40:43], v[76:79]
  v_mfma_f32_16x16x32_bf16 v[80:83], a[28:31], a[40:43], v[80:83]
  v_mfma_f32_16x16x32_bf16 v[80:83], a[16:19], a[36:39], v[80:83]
  v_mfma_f32_16x16x32_bf16 v[80:83], a[4:7], v[24:27], v[80:83]
  v_mfma_f32_16x16x32_bf16 v[84:87], a[8:11], v[24:27], v[84:87]
  s_barrier
  v_mfma_f32_16x16x32_bf16 v[84:87], a[20:23], a[36:39], v[84:87]
  ds_read_b128 v[12:15], v0 offset:16512
  v_mfma_f32_16x16x32_bf16 v[84:87], a[32:35], a[40:43], v[84:87]
  ds_read_b128 v[16:19], v0 offset:17024
  v_mfma_f32_16x16x32_bf16 v[88:91], a[0:3], a[40:43], v[88:91]
  s_waitcnt lgkmcnt(2)
  v_mfma_f32_16x16x32_bf16 v[88:91], a[12:15], a[48:51], v[88:91]
  ds_read_b128 v[20:23], v0 offset:17536
  v_mfma_f32_16x16x32_bf16 v[88:91], a[24:27], a[52:55], v[88:91]
  ds_read_b128 v[24:27], v0 offset:18048
  v_mfma_f32_16x16x32_bf16 v[100:103], a[0:3], a[52:55], v[100:103]
  ds_read_b64_tr_b16 a[0:1], v6 offset:36864
  v_mfma_f32_16x16x32_bf16 v[100:103], a[12:15], a[44:47], v[100:103]
  ds_read_b64_tr_b16 a[2:3], v6 offset:38400
  v_mfma_f32_16x16x32_bf16 v[100:103], a[24:27], a[56:59], v[100:103]
  ds_read_b64_tr_b16 a[12:13], v6 offset:39936
  v_mfma_f32_16x16x32_bf16 v[104:107], a[28:31], a[56:59], v[104:107]
  ds_read_b64_tr_b16 a[14:15], v6 offset:41472
  v_mfma_f32_16x16x32_bf16 v[104:107], a[16:19], a[44:47], v[104:107]
  ds_read_b64_tr_b16 a[24:25], v6 offset:43008
  v_mfma_f32_16x16x32_bf16 v[104:107], a[4:7], a[52:55], v[104:107]
  ds_read_b64_tr_b16 a[26:27], v6 offset:44544
  v_mfma_f32_16x16x32_bf16 v[92:95], a[28:31], a[52:55], v[92:95]
  ds_read_b64_tr_b16 a[28:29], v6 offset:43016
  v_mfma_f32_16x16x32_bf16 v[92:95], a[16:19], a[48:51], v[92:95]
  ds_read_b64_tr_b16 a[30:31], v6 offset:44552
  ds_read_b128 a[36:39], v0 offset:18560
  v_mfma_f32_16x16x32_bf16 v[92:95], a[4:7], a[40:43], v[92:95]
  ds_read_b64_tr_b16 a[16:17], v6 offset:39944
  v_mfma_f32_16x16x32_bf16 v[96:99], a[8:11], a[40:43], v[96:99]
  ds_read_b64_tr_b16 a[18:19], v6 offset:41480
  v_mfma_f32_16x16x32_bf16 v[96:99], a[20:23], a[48:51], v[96:99]
  ds_read_b64_tr_b16 a[4:5], v6 offset:36872
  v_mfma_f32_16x16x32_bf16 v[96:99], a[32:35], a[52:55], v[96:99]
  ds_read_b64_tr_b16 a[6:7], v6 offset:38408
  v_mfma_f32_16x16x32_bf16 v[108:111], a[8:11], a[52:55], v[108:111]
  ds_read_b64_tr_b16 a[8:9], v6 offset:36880
  v_mfma_f32_16x16x32_bf16 v[108:111], a[20:23], a[44:47], v[108:111]
  ds_read_b64_tr_b16 a[10:11], v6 offset:38416
  v_mfma_f32_16x16x32_bf16 v[108:111], a[32:35], a[56:59], v[108:111]
  s_waitcnt lgkmcnt(6)
  ds_read_b64_tr_b16 a[20:21], v6 offset:39952
  v_mfma_f32_16x16x32_bf16 v[112:115], a[0:3], v[12:15], v[112:115]
  ds_read_b64_tr_b16 a[22:23], v6 offset:41488
  v_mfma_f32_16x16x32_bf16 v[112:115], a[12:15], v[16:19], v[112:115]
  ds_read_b64_tr_b16 a[32:33], v6 offset:43024
  v_mfma_f32_16x16x32_bf16 v[112:115], a[24:27], v[20:23], v[112:115]
  ds_read_b64_tr_b16 a[34:35], v6 offset:44560
  v_mfma_f32_16x16x32_bf16 v[124:127], a[0:3], v[20:23], v[124:127]
  v_mfma_f32_16x16x32_bf16 v[124:127], a[12:15], v[24:27], v[124:127]
  ds_read_b128 a[40:43], v0 offset:19072
  v_mfma_f32_16x16x32_bf16 v[124:127], a[24:27], a[36:39], v[124:127]
  s_waitcnt lgkmcnt(7)
  v_mfma_f32_16x16x32_bf16 v[128:131], a[28:31], a[36:39], v[128:131]
  ds_read_b128 a[48:51], v0 offset:19584
  v_mfma_f32_16x16x32_bf16 v[128:131], a[16:19], v[24:27], v[128:131]
  v_mfma_f32_16x16x32_bf16 v[128:131], a[4:7], v[20:23], v[128:131]
  v_mfma_f32_16x16x32_bf16 v[116:119], a[28:31], v[20:23], v[116:119]
  v_mfma_f32_16x16x32_bf16 v[116:119], a[16:19], v[16:19], v[116:119]
  v_mfma_f32_16x16x32_bf16 v[116:119], a[4:7], v[12:15], v[116:119]
  s_waitcnt lgkmcnt(2)
  v_mfma_f32_16x16x32_bf16 v[120:123], a[8:11], v[12:15], v[120:123]
  v_mfma_f32_16x16x32_bf16 v[120:123], a[20:23], v[16:19], v[120:123]
  ds_read_b128 a[52:55], v0 offset:20096
  v_mfma_f32_16x16x32_bf16 v[120:123], a[32:35], v[20:23], v[120:123]
  ds_read_b128 a[44:47], v0 offset:20608
  v_mfma_f32_16x16x32_bf16 v[132:135], a[8:11], v[20:23], v[132:135]
  v_mfma_f32_16x16x32_bf16 v[132:135], a[20:23], v[24:27], v[132:135]
  v_mfma_f32_16x16x32_bf16 v[132:135], a[32:35], a[36:39], v[132:135]
  v_mfma_f32_16x16x32_bf16 v[136:139], a[0:3], a[36:39], v[136:139]
  s_waitcnt lgkmcnt(2)
  v_mfma_f32_16x16x32_bf16 v[136:139], a[12:15], a[40:43], v[136:139]
  v_mfma_f32_16x16x32_bf16 v[136:139], a[24:27], a[48:51], v[136:139]
  v_mfma_f32_16x16x32_bf16 v[140:143], a[28:31], a[48:51], v[140:143]
  v_mfma_f32_16x16x32_bf16 v[140:143], a[16:19], a[40:43], v[140:143]
  ds_read_b128 a[56:59], v0 offset:21120
  v_mfma_f32_16x16x32_bf16 v[140:143], a[4:7], a[36:39], v[140:143]
  ds_read_b128 v[12:15], v0 offset:21632
  v_mfma_f32_16x16x32_bf16 v[144:147], a[8:11], a[36:39], v[144:147]
  v_mfma_f32_16x16x32_bf16 v[144:147], a[20:23], a[40:43], v[144:147]
  v_mfma_f32_16x16x32_bf16 v[144:147], a[32:35], a[48:51], v[144:147]
  v_mfma_f32_16x16x32_bf16 v[148:151], a[0:3], a[48:51], v[148:151]
  s_waitcnt lgkmcnt(2)
  v_mfma_f32_16x16x32_bf16 v[148:151], a[12:15], a[52:55], v[148:151]
  v_mfma_f32_16x16x32_bf16 v[148:151], a[24:27], a[44:47], v[148:151]
  v_mfma_f32_16x16x32_bf16 v[152:155], a[28:31], a[44:47], v[152:155]
  v_mfma_f32_16x16x32_bf16 v[152:155], a[16:19], a[52:55], v[152:155]
  ds_read_b128 v[16:19], v0 offset:22144
  v_mfma_f32_16x16x32_bf16 v[152:155], a[4:7], a[48:51], v[152:155]
  ds_read_b128 v[20:23], v0 offset:22656
  v_mfma_f32_16x16x32_bf16 v[156:159], a[8:11], a[48:51], v[156:159]
  ds_read_b128 v[24:27], v0 offset:23168
  v_mfma_f32_16x16x32_bf16 v[156:159], a[20:23], a[52:55], v[156:159]
  ds_read_b128 a[36:39], v0 offset:23680
  v_mfma_f32_16x16x32_bf16 v[156:159], a[32:35], a[44:47], v[156:159]
  v_mfma_f32_16x16x32_bf16 v[160:163], a[0:3], a[44:47], v[160:163]
  s_waitcnt lgkmcnt(4)
  v_mfma_f32_16x16x32_bf16 v[160:163], a[12:15], a[56:59], v[160:163]
  v_mfma_f32_16x16x32_bf16 v[160:163], a[24:27], v[12:15], v[160:163]
  v_mfma_f32_16x16x32_bf16 v[164:167], a[28:31], v[12:15], v[164:167]
  v_mfma_f32_16x16x32_bf16 v[164:167], a[16:19], a[56:59], v[164:167]
  v_mfma_f32_16x16x32_bf16 v[164:167], a[4:7], a[44:47], v[164:167]
  v_mfma_f32_16x16x32_bf16 v[168:171], a[8:11], a[44:47], v[168:171]
  s_barrier
  v_mfma_f32_16x16x32_bf16 v[168:171], a[20:23], a[56:59], v[168:171]
  ds_read_b128 a[40:43], v0 offset:24768
  v_mfma_f32_16x16x32_bf16 v[168:171], a[32:35], v[12:15], v[168:171]
  ds_read_b128 a[48:51], v0 offset:25280
  v_mfma_f32_16x16x32_bf16 v[172:175], a[0:3], v[12:15], v[172:175]
  s_waitcnt lgkmcnt(2)
  v_mfma_f32_16x16x32_bf16 v[172:175], a[12:15], v[16:19], v[172:175]
  ds_read_b128 a[52:55], v0 offset:25792
  v_mfma_f32_16x16x32_bf16 v[172:175], a[24:27], v[20:23], v[172:175]
  ds_read_b128 a[44:47], v0 offset:26304
  v_mfma_f32_16x16x32_bf16 v[184:187], a[0:3], v[20:23], v[184:187]
  ds_read_b64_tr_b16 a[0:1], v6 offset:0
L_pg2:
  s_cmp_lg_u32 s32, 0
  s_cbranch_scc1 L_pr2
  v_mfma_f32_16x16x32_bf16 v[184:187], a[12:15], v[24:27], v[184:187]
  ds_read_b64_tr_b16 a[2:3], v6 offset:1536
  v_mfma_f32_16x16x32_bf16 v[184:187], a[24:27], a[36:39], v[184:187]
  ds_read_b64_tr_b16 a[12:13], v6 offset:3072
  v_mfma_f32_16x16x32_bf16 v[188:191], a[28:31], a[36:39], v[188:191]
  ds_read_b64_tr_b16 a[14:15], v6 offset:4608
  v_mfma_f32_16x16x32_bf16 v[188:191], a[16:19], v[24:27], v[188:191]
  ds_read_b64_tr_b16 a[24:25], v6 offset:6144
  v_mfma_f32_16x16x32_bf16 v[188:191], a[4:7], v[20:23], v[188:191]
  ds_read_b64_tr_b16 a[26:27], v6 offset:7680
  v_mfma_f32_16x16x32_bf16 v[176:179], a[28:31], v[20:23], v[176:179]
  ds_read_b64_tr_b16 a[28:29], v6 offset:6152
  v_mfma_f32_16x16x32_bf16 v[176:179], a[16:19], v[16:19], v[176:179]
  ds_read_b64_tr_b16 a[30:31], v6 offset:7688
  ds_read_b128 a[56:59], v0 offset:26816
  v_mfma_f32_16x16x32_bf16 v[176:179], a[4:7], v[12:15], v[176:179]
  ds_read_b64_tr_b16 a[16:17], v6 offset:3080
  v_mfma_f32_16x16x32_bf16 v[180:183], a[8:11], v[12:15], v[180:183]
  ds_read_b64_tr_b16 a[18:19], v6 offset:4616
  v_mfma_f32_16x16x32_bf16 v[180:183], a[20:23], v[16:19], v[180:183]
  ds_read_b64_tr_b16 a[4:5], v6 offset:8
  v_mfma_f32_16x16x32_bf16 v[180:183], a[32:35], v[20:23], v[180:183]
  ds_read_b64_tr_b16 a[6:7], v6 offset:1544
  v_mfma_f32_16x16x32_bf16 v[192:195], a[8:11], v[20:23], v[192:195]
  ds_read_b64_tr_b16 a[8:9], v6 offset:16
  v_mfma_f32_16x16x32_bf16 v[192:195], a[20:23], v[24:27], v[192:195]
  ds_read_b64_tr_b16 a[10:11], v6 offset:1552
  v_mfma_f32_16x16x32_bf16 v[192:195], a[32:35], a[36:39], v[192:195]
  s_waitcnt lgkmcnt(6)
  ds_read_b64_tr_b16 a[20:21], v6 offset:3088
  v_mfma_f32_16x16x32_bf16 v[112:115], a[0:3], a[40:43], v[112:115]
  ds_read_b64_tr_b16 a[22:23], v6 offset:4624
  v_mfma_f32_16x16x32_bf16 v[112:115], a[12:15], a[48:51], v[112:115]
  ds_read_b64_tr_b16 a[32:33], v6 offset:6160
  v_mfma_f32_16x16x32_bf16 v[112:115], a[24:27], a[52:55], v[112:115]
  ds_read_b64_tr_b16 a[34:35], v6 offset:7696
  v_mfma_f32_16x16x32_bf16 v[124:127], a[0:3], a[52:55], v[124:127]
  ds_read_b128 v[12:15], v0 offset:27328
  ds_read_b128 v[16:19], v0 offset:27840
  v_mfma_f32_16x16x32_bf16 v[124:127], a[12:15], a[44:47], v[124:127]
  ds_read_b128 v[20:23], v0 offset:28352
  ds_read_b128 v[24:27], v0 offset:28864
  v_mfma_f32_16x16x32_bf16 v[124:127], a[24:27], a[56:59], v[124:127]
  s_waitcnt lgkmcnt(10)
  v_mfma_f32_16x16x32_bf16 v[128:131], a[28:31], a[56:59], v[128:131]
  v_mfma_f32_16x16x32_bf16 v[128:131], a[16:19], a[44:47], v[128:131]
  v_mfma_f32_16x16x32_bf16 v[128:131], a[4:7], a[52:55], v[128:131]
  v_mfma_f32_16x16x32_bf16 v[116:119], a[28:31], a[52:55], v[116:119]
  s_barrier
  v_mfma_f32_16x16x32_bf16 v[116:119], a[16:19], a[48:51], v[116:119]
  v_mfma_f32_16x16x32_bf16 v[116:119], a[4:7], a[40:43], v[116:119]
  s_waitcnt lgkmcnt(4)
  v_mfma_f32_16x16x32_bf16 v[120:123], a[8:11], a[40:43], v[120:123]
  v_mfma_f32_16x16x32_bf16 v[120:123], a[20:23], a[48:51], v[120:123]
  v_mfma_f32_16x16x32_bf16 v[120:123], a[32:35], a[52:55], v[120:123]
  v_mfma_f32_16x16x32_bf16 v[132:135], a[8:11], a[52:55], v[132:135]
  v_mfma_f32_16x16x32_bf16 v[132:135], a[20:23], a[44:47], v[132:135]
  v_mfma_f32_16x16x32_bf16 v[132:135], a[32:35], a[56:59], v[132:135]
  v_mfma_f32_16x16x32_bf16 v[136:139], a[0:3], a[56:59], v[136:139]
  s_waitcnt lgkmcnt(2)
  v_mfma_f32_16x16x32_bf16 v[136:139], a[12:15], v[12:15], v[136:139]
  v_mfma_f32_16x16x32_bf16 v[136:139], a[24:27], v[16:19], v[136:139]
  v_mfma_f32_16x16x32_bf16 v[140:143], a[28:31], v[16:19], v[140:143]
  v_mfma_f32_16x16x32_bf16 v[140:143], a[16:19], v[12:15], v[140:143]
  ds_read_b128 a[36:39], v0 offset:29376
  v_mfma_f32_16x16x32_bf16 v[140:143], a[4:7], a[56:59], v[140:143]
  ds_read_b128 a[40:43], v0 offset:29888
  v_mfma_f32_16x16x32_bf16 v[144:147], a[8:11], a[56:59], v[144:147]
  v_mfma_f32_16x16x32_bf16 v[144:147], a[20:23], v[12:15], v[144:147]
  v_mfma_f32_16x16x32_bf16 v[144:147], a[32:35], v[16:19], v[144:147]
  v_mfma_f32_16x16x32_bf16 v[148:151], a[0:3], v[16:19], v[148:151]
  s_waitcnt lgkmcnt(2)
  v_mfma_f32_16x16x32_bf16 v[148:151], a[12:15], v[20:23], v[148:151]
  v_mfma_f32_16x16x32_bf16 v[148:151], a[24:27], v[24:27], v[148:151]
  v_mfma_f32_16x16x32_bf16 v[152:155], a[28:31], v[24:27], v[152:155]
  v_mfma_f32_16x16x32_bf16 v[152:155], a[16:19], v[20:23], v[152:155]
  ds_read_b128 a[48:51], v0 offset:30400
  v_mfma_f32_16x16x32_bf16 v[152:155], a[4:7], v[16:19], v[152:155]
  ds_read_b128 a[52:55], v0 offset:30912
  v_mfma_f32_16x16x32_bf16 v[156:159], a[8:11], v[16:19], v[156:159]
  ds_read_b128 a[44:47], v0 offset:31424
  v_mfma_f32_16x16x32_bf16 v[156:159], a[20:23], v[20:23], v[156:159]
  ds_read_b128 a[56:59], v0 offset:31936
  v_mfma_f32_16x16x32_bf16 v[156:159], a[32:35], v[24:27], v[156:159]
  v_mfma_f32_16x16x32_bf16 v[160:163], a[0:3], v[24:27], v[160:163]
  s_waitcnt lgkmcnt(4)
  v_mfma_f32_16x16x32_bf16 v[160:163], a[12:15], a[36:39], v[160:163]
  v_mfma_f32_16x16x32_bf16 v[160:163], a[24:27], a[40:43], v[160:163]
  v_mfma_f32_16x16x32_bf16 v[164:167], a[28:31], a[40:43], v[164:167]
  v_mfma_f32_16x16x32_bf16 v[164:167], a[16:19], a[36:39], v[164:167]
  v_mfma_f32_16x16x32_bf16 v[164:167], a[4:7], v[24:27], v[164:167]
  v_mfma_f32_16x16x32_bf16 v[168:171], a[8:11], v[24:27], v[168:171]
  s_barrier
  v_mfma_f32_16x16x32_bf16 v[168:171], a[20:23], a[36:39], v[168:171]
  ds_read_b128 v[12:15], v0 offset:0
  v_mfma_f32_16x16x32_bf16 v[168:171], a[32:35], a[40:43], v[168:171]
  ds_read_b128 v[16:19], v0 offset:512
  v_mfma_f32_16x16x32_bf16 v[172:175], a[0:3], a[40:43], v[172:175]
  s_waitcnt lgkmcnt(2)
  v_mfma_f32_16x16x32_bf16 v[172:175], a[12:15], a[48:51], v[172:175]
  ds_read_b128 v[20:23], v0 offset:1024
  v_mfma_f32_16x16x32_bf16 v[172:175], a[24:27], a[52:55], v[172:175]
  ds_read_b128 v[24:27], v0 offset:1536
  v_mfma_f32_16x16x32_bf16 v[184:187], a[0:3], a[52:55], v[184:187]
  ds_read_b64_tr_b16 a[0:1], v7 offset:0
  v_mfma_f32_16x16x32_bf16 v[184:187], a[12:15], a[44:47], v[184:187]
  ds_read_b64_tr_b16 a[2:3], v7 offset:1536
  v_mfma_f32_16x16x32_bf16 v[184:187], a[24:27], a[56:59], v[184:187]
  ds_read_b64_tr_b16 a[12:13], v7 offset:3072
  v_mfma_f32_16x16x32_bf16 v[188:191], a[28:31], a[56:59], v[188:191]
  ds_read_b64_tr_b16 a[14:15], v7 offset:4608
  v_mfma_f32_16x16x32_bf16 v[188:191], a[16:19], a[44:47], v[188:191]
  ds_read_b64_tr_b16 a[24:25], v7 offset:6144
  v_mfma_f32_16x16x32_bf16 v[188:191], a[4:7], a[52:55], v[188:191]
  ds_read_b64_tr_b16 a[26:27], v7 offset:7680
  v_mfma_f32_16x16x32_bf16 v[176:179], a[28:31], a[52:55], v[176:179]
  ds_read_b64_tr_b16 a[28:29], v7 offset:6152
  v_mfma_f32_16x16x32_bf16 v[176:179], a[16:19], a[48:51], v[176:179]
  ds_read_b64_tr_b16 a[30:31], v7 offset:7688
  ds_read_b128 a[36:39], v0 offset:2048
  v_mfma_f32_16x16x32_bf16 v[176:179], a[4:7], a[40:43], v[176:179]
  ds_read_b64_tr_b16 a[16:17], v7 offset:3080
  v_mfma_f32_16x16x32_bf16 v[180:183], a[8:11], a[40:43], v[180:183]
  ds_read_b64_tr_b16 a[18:19], v7 offset:4616
  v_mfma_f32_16x16x32_bf16 v[180:183], a[20:23], a[48:51], v[180:183]
  ds_read_b64_tr_b16 a[4:5], v7 offset:8
  v_mfma_f32_16x16x32_bf16 v[180:183], a[32:35], a[52:55], v[180:183]
  ds_read_b64_tr_b16 a[6:7], v7 offset:1544
  v_mfma_f32_16x16x32_bf16 v[192:195], a[8:11], a[52:55], v[192:195]
  ds_read_b64_tr_b16 a[8:9], v7 offset:16
  v_mfma_f32_16x16x32_bf16 v[192:195], a[20:23], a[44:47], v[192:195]
  ds_read_b64_tr_b16 a[10:11], v7 offset:1552
  v_mfma_f32_16x16x32_bf16 v[192:195], a[32:35], a[56:59], v[192:195]
  s_waitcnt lgkmcnt(6)
  ds_read_b64_tr_b16 a[20:21], v7 offset:3088
  v_mfma_f32_16x16x32_bf16 v[28:31], a[0:3], v[12:15], v[28:31]
  ds_read_b64_tr_b16 a[22:23], v7 offset:4624
  v_mfma_f32_16x16x32_bf16 v[28:31], a[12:15], v[16:19], v[28:31]
  ds_read_b64_tr_b16 a[32:33], v7 offset:6160
  v_mfma_f32_16x16x32_bf16 v[28:31], a[24:27], v[20:23], v[28:31]
  ds_read_b64_tr_b16 a[34:35], v7 offset:7696
  v_mfma_f32_16x16x32_bf16 v[40:43], a[0:3], v[20:23], v[40:43]
  v_mfma_f32_16x16x32_bf16 v[40:43], a[12:15], v[24:27], v[40:43]
  ds_read_b128 a[40:43], v0 offset:2560
  v_mfma_f32_16x16x32_bf16 v[40:43], a[24:27], a[36:39], v[40:43]
  s_waitcnt lgkmcnt(7)
  v_mfma_f32_16x16x32_bf16 v[44:47], a[28:31], a[36:39], v[44:47]
  ds_read_b128 a[48:51], v0 offset:3072
  v_mfma_f32_16x16x32_bf16 v[44:47], a[16:19], v[24:27], v[44:47]
  v_mfma_f32_16x16x32_bf16 v[44:47], a[4:7], v[20:23], v[44:47]
  v_mfma_f32_16x16x32_bf16 v[32:35], a[28:31], v[20:23], v[32:35]
  v_mfma_f32_16x16x32_bf16 v[32:35], a[16:19], v[16:19], v[32:35]
  v_mfma_f32_16x16x32_bf16 v[32:35], a[4:7], v[12:15], v[32:35]
  s_waitcnt lgkmcnt(2)
  v_mfma_f32_16x16x32_bf16 v[36:39], a[8:11], v[12:15], v[36:39]
  v_mfma_f32_16x16x32_bf16 v[36:39], a[20:23], v[16:19], v[36:39]
  ds_read_b128 a[52:55], v0 offset:3584
  v_mfma_f32_16x16x32_bf16 v[36:39], a[32:35], v[20:23], v[36:39]
  ds_read_b128 a[44:47], v0 offset:4096
  v_mfma_f32_16x16x32_bf16 v[48:51], a[8:11], v[20:23], v[48:51]
  v_mfma_f32_16x16x32_bf16 v[48:51], a[20:23], v[24:27], v[48:51]
  v_mfma_f32_16x16x32_bf16 v[48:51], a[32:35], a[36:39], v[48:51]
  v_mfma_f32_16x16x32_bf16 v[52:55], a[0:3], a[36:39], v[52:55]
  s_waitcnt lgkmcnt(2)
  v_mfma_f32_16x16x32_bf16 v[52:55], a[12:15], a[40:43], v[52:55]
  s_waitcnt vmcnt(0)
  v_mfma_f32_16x16x32_bf16 v[52:55], a[24:27], a[48:51], v[52:55]
  v_mfma_f32_16x16x32_bf16 v[56:59], a[28:31], a[48:51], v[56:59]
  v_mfma_f32_16x16x32_bf16 v[56:59], a[16:19], a[40:43], v[56:59]
  ds_read_b128 a[56:59], v0 offset:4608
  v_mfma_f32_16x16x32_bf16 v[56:59], a[4:7], a[36:39], v[56:59]
  ds_read_b128 v[12:15], v0 offset:5120
  v_mfma_f32_16x16x32_bf16 v[60:63], a[8:11], a[36:39], v[60:63]
  v_mfma_f32_16x16x32_bf16 v[60:63], a[20:23], a[40:43], v[60:63]
  v_mfma_f32_16x16x32_bf16 v[60:63], a[32:35], a[48:51], v[60:63]
  v_mfma_f32_16x16x32_bf16 v[64:67], a[0:3], a[48:51], v[64:67]
  s_waitcnt lgkmcnt(2)
  v_mfma_f32_16x16x32_bf16 v[64:67], a[12:15], a[52:55], v[64:67]
  v_mfma_f32_16x16x32_bf16 v[64:67], a[24:27], a[44:47], v[64:67]
  v_mfma_f32_16x16x32_bf16 v[68:71], a[28:31], a[44:47], v[68:71]
  v_mfma_f32_16x16x32_bf16 v[68:71], a[16:19], a[52:55], v[68:71]
  ds_read_b128 v[16:19], v0 offset:5632
  v_mfma_f32_16x16x32_bf16 v[68:71], a[4:7], a[48:51], v[68:71]
  ds_read_b128 v[20:23], v0 offset:6144
  v_mfma_f32_16x16x32_bf16 v[72:75], a[8:11], a[48:51], v[72:75]
  ds_read_b128 v[24:27], v0 offset:6656
  v_mfma_f32_16x16x32_bf16 v[72:75], a[20:23], a[52:55], v[72:75]
  ds_read_b128 a[36:39], v0 offset:7168
  v_mfma_f32_16x16x32_bf16 v[72:75], a[32:35], a[44:47], v[72:75]
  v_mfma_f32_16x16x32_bf16 v[76:79], a[0:3], a[44:47], v[76:79]
  s_waitcnt lgkmcnt(4)
  v_mfma_f32_16x16x32_bf16 v[76:79], a[12:15], a[56:59], v[76:79]
  v_mfma_f32_16x16x32_bf16 v[76:79], a[24:27], v[12:15], v[76:79]
  v_mfma_f32_16x16x32_bf16 v[80:83], a[28:31], v[12:15], v[80:83]
  v_mfma_f32_16x16x32_bf16 v[80:83], a[16:19], a[56:59], v[80:83]
  v_mfma_f32_16x16x32_bf16 v[80:83], a[4:7], a[44:47], v[80:83]
  v_mfma_f32_16x16x32_bf16 v[84:87], a[8:11], a[44:47], v[84:87]
  s_barrier
  v_mfma_f32_16x16x32_bf16 v[84:87], a[20:23], a[56:59], v[84:87]
  ds_read_b128 a[40:43], v0 offset:8256
  v_mfma_f32_16x16x32_bf16 v[84:87], a[32:35], v[12:15], v[84:87]
  ds_read_b128 a[48:51], v0 offset:8768
  v_mfma_f32_16x16x32_bf16 v[88:91], a[0:3], v[12:15], v[88:91]
  s_waitcnt lgkmcnt(2)
  v_mfma_f32_16x16x32_bf16 v[88:91], a[12:15], v[16:19], v[88:91]
  ds_read_b128 a[52:55], v0 offset:9280
  v_mfma_f32_16x16x32_bf16 v[88:91], a[24:27], v[20:23], v[88:91]
  ds_read_b128 a[44:47], v0 offset:9792
  v_mfma_f32_16x16x32_bf16 v[100:103], a[0:3], v[20:23], v[100:103]
  ds_read_b64_tr_b16 a[0:1], v6 offset:36864
  v_mfma_f32_16x16x32_bf16 v[100:103], a[12:15], v[24:27], v[100:103]
  ds_read_b64_tr_b16 a[2:3], v6 offset:38400
  v_mfma_f32_16x16x32_bf16 v[100:103], a[24:27], a[36:39], v[100:103]
  ds_read_b64_tr_b16 a[12:13], v6 offset:39936
  v_mfma_f32_16x16x32_bf16 v[104:107], a[28:31], a[36:39], v[104:107]
  ds_read_b64_tr_b16 a[14:15], v6 offset:41472
  v_mfma_f32_16x16x32_bf16 v[104:107], a[16:19], v[24:27], v[104:107]
  ds_read_b64_tr_b16 a[24:25], v6 offset:43008
  v_mfma_f32_16x16x32_bf16 v[104:107], a[4:7], v[20:23], v[104:107]
  ds_read_b64_tr_b16 a[26:27], v6 offset:44544
  v_mfma_f32_16x16x32_bf16 v[92:95], a[28:31], v[20:23], v[92:95]
  ds_read_b64_tr_b16 a[28:29], v6 offset:43016
  v_mfma_f32_16x16x32_bf16 v[92:95], a[16:19], v[16:19], v[92:95]
  ds_read_b64_tr_b16 a[30:31], v6 offset:44552
  ds_read_b128 a[56:59], v0 offset:10304
  v_mfma_f32_16x16x32_bf16 v[92:95], a[4:7], v[12:15], v[92:95]
  ds_read_b64_tr_b16 a[16:17], v6 offset:39944
  v_mfma_f32_16x16x32_bf16 v[96:99], a[8:11], v[12:15], v[96:99]
  ds_read_b64_tr_b16 a[18:19], v6 offset:41480
  v_mfma_f32_16x16x32_bf16 v[96:99], a[20:23], v[16:19], v[96:99]
  ds_read_b64_tr_b16 a[4:5], v6 offset:36872
  v_mfma_f32_16x16x32_bf16 v[96:99], a[32:35], v[20:23], v[96:99]
  ds_read_b64_tr_b16 a[6:7], v6 offset:38408
  v_mfma_f32_16x16x32_bf16 v[108:111], a[8:11], v[20:23], v[108:111]
  ds_read_b64_tr_b16 a[8:9], v6 offset:36880
  v_mfma_f32_16x16x32_bf16 v[108:111], a[20:23], v[24:27], v[108:111]
  ds_read_b64_tr_b16 a[10:11], v6 offset:38416
  v_mfma_f32_16x16x32_bf16 v[108:111], a[32:35], a[36:39], v[108:111]
  s_waitcnt lgkmcnt(6)
  ds_read_b64_tr_b16 a[20:21], v6 offset:39952
  v_mfma_f32_16x16x32_bf16 v[28:31], a[0:3], a[40:43], v[28:31]
  ds_read_b64_tr_b16 a[22:23], v6 offset:41488
  v_mfma_f32_16x16x32_bf16 v[28:31], a[12:15], a[48:51], v[28:31]
  ds_read_b64_tr_b16 a[32:33], v6 offset:43024
  v_mfma_f32_16x16x32_bf16 v[28:31], a[24:27], a[52:55], v[28:31]
  ds_read_b64_tr_b16 a[34:35], v6 offset:44560
  v_mfma_f32_16x16x32_bf16 v[40:43], a[0:3], a[52:55], v[40:43]
  ds_read_b128 v[12:15], v0 offset:10816
  ds_read_b128 v[16:19], v0 offset:11328
  v_mfma_f32_16x16x32_bf16 v[40:43], a[12:15], a[44:47], v[40:43]
  ds_read_b128 v[20:23], v0 offset:11840
  ds_read_b128 v[24:27], v0 offset:12352
  v_mfma_f32_16x16x32_bf16 v[40:43], a[24:27], a[56:59], v[40:43]
  s_waitcnt lgkmcnt(10)
  v_mfma_f32_16x16x32_bf16 v[44:47], a[28:31], a[56:59], v[44:47]
  v_mfma_f32_16x16x32_bf16 v[44:47], a[16:19], a[44:47], v[44:47]
  v_mfma_f32_16x16x32_bf16 v[44:47], a[4:7], a[52:55], v[44:47]
  v_mfma_f32_16x16x32_bf16 v[32:35], a[28:31], a[52:55], v[32:35]
  s_barrier
  v_mfma_f32_16x16x32_bf16 v[32:35], a[16:19], a[48:51], v[32:35]
  v_mfma_f32_16x16x32_bf16 v[32:35], a[4:7], a[40:43], v[32:35]
  s_waitcnt lgkmcnt(4)
  v_mfma_f32_16x16x32_bf16 v[36:39], a[8:11], a[40:43], v[36:39]
  v_mfma_f32_16x16x32_bf16 v[36:39], a[20:23], a[48:51], v[36:39]
  v_mfma_f32_16x16x32_bf16 v[36:39], a[32:35], a[52:55], v[36:39]
  v_mfma_f32_16x16x32_bf16 v[48:51], a[8:11], a[52:55], v[48:51]
  v_mfma_f32_16x16x32_bf16 v[48:51], a[20:23], a[44:47], v[48:51]
  v_mfma_f32_16x16x32_bf16 v[48:51], a[32:35], a[56:59], v[48:51]
  v_mfma_f32_16x16x32_bf16 v[52:55], a[0:3], a[56:59], v[52:55]
  s_waitcnt lgkmcnt(2)
  v_mfma_f32_16x16x32_bf16 v[52:55], a[12:15], v[12:15], v[52:55]
  v_mfma_f32_16x16x32_bf16 v[52:55], a[24:27], v[16:19], v[52:55]
  v_mfma_f32_16x16x32_bf16 v[56:59], a[28:31], v[16:19], v[56:59]
  v_mfma_f32_16x16x32_bf16 v[56:59], a[16:19], v[12:15], v[56:59]
  ds_read_b128 a[36:39], v0 offset:12864
  v_mfma_f32_16x16x32_bf16 v[56:59], a[4:7], a[56:59], v[56:59]
  ds_read_b128 a[40:43], v0 offset:13376
  v_mfma_f32_16x16x32_bf16 v[60:63], a[8:11], a[56:59], v[60:63]
  v_mfma_f32_16x16x32_bf16 v[60:63], a[20:23], v[12:15], v[60:63]
  v_mfma_f32_16x16x32_bf16 v[60:63], a[32:35], v[16:19], v[60:63]
  v_mfma_f32_16x16x32_bf16 v[64:67], a[0:3], v[16:19], v[64:67]
  s_waitcnt lgkmcnt(2)
  v_mfma_f32_16x16x32_bf16 v[64:67], a[12:15], v[20:23], v[64:67]
  v_mfma_f32_16x16x32_bf16 v[64:67], a[24:27], v[24:27], v[64:67]
  v_mfma_f32_16x16x32_bf16 v[68:71], a[28:31], v[24:27], v[68:71]
  v_mfma_f32_16x16x32_bf16 v[68:71], a[16:19], v[20:23], v[68:71]
  ds_read_b128 a[48:51], v0 offset:13888
  v_mfma_f32_16x16x32_bf16 v[68:71], a[4:7], v[16:19], v[68:71]
  ds_read_b128 a[52:55], v0 offset:14400
  v_mfma_f32_16x16x32_bf16 v[72:75], a[8:11], v[16:19], v[72:75]
  ds_read_b128 a[44:47], v0 offset:14912
  v_mfma_f32_16x16x32_bf16 v[72:75], a[20:23], v[20:23], v[72:75]
  ds_read_b128 a[56:59], v0 offset:15424
  v_mfma_f32_16x16x32_bf16 v[72:75], a[32:35], v[24:27], v[72:75]
  v_mfma_f32_16x16x32_bf16 v[76:79], a[0:3], v[24:27], v[76:79]
  s_waitcnt lgkmcnt(4)
  v_mfma_f32_16x16x32_bf16 v[76:79], a[12:15], a[36:39], v[76:79]
  v_mfma_f32_16x16x32_bf16 v[76:79], a[24:27], a[40:43], v[76:79]
  v_mfma_f32_16x16x32_bf16 v[80:83], a[28:31], a[40:43], v[80:83]
  v_mfma_f32_16x16x32_bf16 v[80:83], a[16:19], a[36:39], v[80:83]
  v_mfma_f32_16x16x32_bf16 v[80:83], a[4:7], v[24:27], v[80:83]
  v_mfma_f32_16x16x32_bf16 v[84:87], a[8:11], v[24:27], v[84:87]
  s_barrier
  v_mfma_f32_16x16x32_bf16 v[84:87], a[20:23], a[36:39], v[84:87]
  ds_read_b128 v[12:15], v0 offset:16512
  v_mfma_f32_16x16x32_bf16 v[84:87], a[32:35], a[40:43], v[84:87]
  ds_read_b128 v[16:19], v0 offset:17024
  v_mfma_f32_16x16x32_bf16 v[88:91], a[0:3], a[40:43], v[88:91]
  s_waitcnt lgkmcnt(2)
  v_mfma_f32_16x16x32_bf16 v[88:91], a[12:15], a[48:51], v[88:91]
  ds_read_b128 v[20:23], v0 offset:17536
  v_mfma_f32_16x16x32_bf16 v[88:91], a[24:27], a[52:55], v[88:91]
  ds_read_b128 v[24:27], v0 offset:18048
  v_mfma_f32_16x16x32_bf16 v[100:103], a[0:3], a[52:55], v[100:103]
  ds_read_b64_tr_b16 a[0:1], v6 offset:0
  v_mfma_f32_16x16x32_bf16 v[100:103], a[12:15], a[44:47], v[100:103]
  ds_read_b64_tr_b16 a[2:3], v6 offset:1536
  v_mfma_f32_16x16x32_bf16 v[100:103], a[24:27], a[56:59], v[100:103]
  ds_read_b64_tr_b16 a[12:13], v6 offset:3072
  v_mfma_f32_16x16x32_bf16 v[104:107], a[28:31], a[56:59], v[104:107]
  ds_read_b64_tr_b16 a[14:15], v6 offset:4608
  v_mfma_f32_16x16x32_bf16 v[104:107], a[16:19], a[44:47], v[104:107]
  ds_read_b64_tr_b16 a[24:25], v6 offset:6144
  v_mfma_f32_16x16x32_bf16 v[104:107], a[4:7], a[52:55], v[104:107]
  ds_read_b64_tr_b16 a[26:27], v6 offset:7680
  v_mfma_f32_16x16x32_bf16 v[92:95], a[28:31], a[52:55], v[92:95]
  ds_read_b64_tr_b16 a[28:29], v6 offset:6152
  v_mfma_f32_16x16x32_bf16 v[92:95], a[16:19], a[48:51], v[92:95]
  ds_read_b64_tr_b16 a[30:31], v6 offset:7688
  ds_read_b128 a[36:39], v0 offset:18560
  v_mfma_f32_16x16x32_bf16 v[92:95], a[4:7], a[40:43], v[92:95]
  ds_read_b64_tr_b16 a[16:17], v6 offset:3080
  v_mfma_f32_16x16x32_bf16 v[96:99], a[8:11], a[40:43], v[96:99]
  ds_read_b64_tr_b16 a[18:19], v6 offset:4616
  v_mfma_f32_16x16x32_bf16 v[96:99], a[20:23], a[48:51], v[96:99]
  ds_read_b64_tr_b16 a[4:5], v6 offset:8
  v_mfma_f32_16x16x32_bf16 v[96:99], a[32:35], a[52:55], v[96:99]
  ds_read_b64_tr_b16 a[6:7], v6 offset:1544
  v_mfma_f32_16x16x32_bf16 v[108:111], a[8:11], a[52:55], v[108:111]
  ds_read_b64_tr_b16 a[8:9], v6 offset:16
  v_mfma_f32_16x16x32_bf16 v[108:111], a[20:23], a[44:47], v[108:111]
  ds_read_b64_tr_b16 a[10:11], v6 offset:1552
  v_mfma_f32_16x16x32_bf16 v[108:111], a[32:35], a[56:59], v[108:111]
  s_waitcnt lgkmcnt(6)
  ds_read_b64_tr_b16 a[20:21], v6 offset:3088
  v_mfma_f32_16x16x32_bf16 v[28:31], a[0:3], v[12:15], v[28:31]
  ds_read_b64_tr_b16 a[22:23], v6 offset:4624
  v_mfma_f32_16x16x32_bf16 v[28:31], a[12:15], v[16:19], v[28:31]
  ds_read_b64_tr_b16 a[32:33], v6 offset:6160
  v_mfma_f32_16x16x32_bf16 v[28:31], a[24:27], v[20:23], v[28:31]
  ds_read_b64_tr_b16 a[34:35], v6 offset:7696
  v_mfma_f32_16x16x32_bf16 v[40:43], a[0:3], v[20:23], v[40:43]
  v_mfma_f32_16x16x32_bf16 v[40:43], a[12:15], v[24:27], v[40:43]
  ds_read_b128 a[40:43], v0 offset:19072
  v_mfma_f32_16x16x32_bf16 v[40:43], a[24:27], a[36:39], v[40:43]
  s_waitcnt lgkmcnt(7)
  v_mfma_f32_16x16x32_bf16 v[44:47], a[28:31], a[36:39], v[44:47]
  ds_read_b128 a[48:51], v0 offset:19584
  v_mfma_f32_16x16x32_bf16 v[44:47], a[16:19], v[24:27], v[44:47]
  v_mfma_f32_16x16x32_bf16 v[44:47], a[4:7], v[20:23], v[44:47]
  v_mfma_f32_16x16x32_bf16 v[32:35], a[28:31], v[20:23], v[32:35]
  v_mfma_f32_16x16x32_bf16 v[32:35], a[16:19], v[16:19], v[32:35]
  v_mfma_f32_16x16x32_bf16 v[32:35], a[4:7], v[12:15], v[32:35]
  s_waitcnt lgkmcnt(2)
  v_mfma_f32_16x16x32_bf16 v[36:39], a[8:11], v[12:15], v[36:39]
  v_mfma_f32_16x16x32_bf16 v[36:39], a[20:23], v[16:19], v[36:39]
  ds_read_b128 a[52:55], v0 offset:20096
  v_mfma_f32_16x16x32_bf16 v[36:39], a[32:35], v[20:23], v[36:39]
  ds_read_b128 a[44:47], v0 offset:20608
  v_mfma_f32_16x16x32_bf16 v[48:51], a[8:11], v[20:23], v[48:51]
  v_mfma_f32_16x16x32_bf16 v[48:51], a[20:23], v[24:27], v[48:51]
  v_mfma_f32_16x16x32_bf16 v[48:51], a[32:35], a[36:39], v[48:51]
  v_mfma_f32_16x16x32_bf16 v[52:55], a[0:3], a[36:39], v[52:55]
  s_waitcnt lgkmcnt(2)
  v_mfma_f32_16x16x32_bf16 v[52:55], a[12:15], a[40:43], v[52:55]
  v_mfma_f32_16x16x32_bf16 v[52:55], a[24:27], a[48:51], v[52:55]
  v_mfma_f32_16x16x32_bf16 v[56:59], a[28:31], a[48:51], v[56:59]
  v_mfma_f32_16x16x32_bf16 v[56:59], a[16:19], a[40:43], v[56:59]
  ds_read_b128 a[56:59], v0 offset:21120
  v_mfma_f32_16x16x32_bf16 v[56:59], a[4:7], a[36:39], v[56:59]
  ds_read_b128 v[12:15], v0 offset:21632
  v_mfma_f32_16x16x32_bf16 v[60:63], a[8:11], a[36:39], v[60:63]
  v_mfma_f32_16x16x32_bf16 v[60:63], a[20:23], a[40:43], v[60:63]
  v_mfma_f32_16x16x32_bf16 v[60:63], a[32:35], a[48:51], v[60:63]
  v_mfma_f32_16x16x32_bf16 v[64:67], a[0:3], a[48:51], v[64:67]
  s_waitcnt lgkmcnt(2)
  v_mfma_f32_16x16x32_bf16 v[64:67], a[12:15], a[52:55], v[64:67]
  v_mfma_f32_16x16x32_bf16 v[64:67], a[24:27], a[44:47], v[64:67]
  v_mfma_f32_16x16x32_bf16 v[68:71], a[28:31], a[44:47], v[68:71]
  v_mfma_f32_16x16x32_bf16 v[68:71], a[16:19], a[52:55], v[68:71]
  ds_read_b128 v[16:19], v0 offset:22144
  v_mfma_f32_16x16x32_bf16 v[68:71], a[4:7], a[48:51], v[68:71]
  ds_read_b128 v[20:23], v0 offset:22656
  v_mfma_f32_16x16x32_bf16 v[72:75], a[8:11], a[48:51], v[72:75]
  ds_read_b128 v[24:27], v0 offset:23168
  v_mfma_f32_16x16x32_bf16 v[72:75], a[20:23], a[52:55], v[72:75]
  ds_read_b128 a[36:39], v0 offset:23680
  v_mfma_f32_16x16x32_bf16 v[72:75], a[32:35], a[44:47], v[72:75]
  v_mfma_f32_16x16x32_bf16 v[76:79], a[0:3], a[44:47], v[76:79]
  s_waitcnt lgkmcnt(4)
  v_mfma_f32_16x16x32_bf16 v[76:79], a[12:15], a[56:59], v[76:79]
  v_mfma_f32_16x16x32_bf16 v[76:79], a[24:27], v[12:15], v[76:79]
  v_mfma_f32_16x16x32_bf16 v[80:83], a[28:31], v[12:15], v[80:83]
  v_mfma_f32_16x16x32_bf16 v[80:83], a[16:19], a[56:59], v[80:83]
  v_mfma_f32_16x16x32_bf16 v[80:83], a[4:7], a[44:47], v[80:83]
  v_mfma_f32_16x16x32_bf16 v[84:87], a[8:11], a[44:47], v[84:87]
  s_barrier
  v_mfma_f32_16x16x32_bf16 v[84:87], a[20:23], a[56:59], v[84:87]
  ds_read_b128 a[40:43], v0 offset:24768
  v_mfma_f32_16x16x32_bf16 v[84:87], a[32:35], v[12:15], v[84:87]
  ds_read_b128 a[48:51], v0 offset:25280
  v_mfma_f32_16x16x32_bf16 v[88:91], a[0:3], v[12:15], v[88:91]
  s_waitcnt lgkmcnt(2)
  v_mfma_f32_16x16x32_bf16 v[88:91], a[12:15], v[16:19], v[88:91]
  ds_read_b128 a[52:55], v0 offset:25792
  v_mfma_f32_16x16x32_bf16 v[88:91], a[24:27], v[20:23], v[88:91]
  ds_read_b128 a[44:47], v0 offset:26304
  v_mfma_f32_16x16x32_bf16 v[100:103], a[0:3], v[20:23], v[100:103]
  ds_read_b64_tr_b16 a[0:1], v7 offset:0
  v_mfma_f32_16x16x32_bf16 v[100:103], a[12:15], v[24:27], v[100:103]
  ds_read_b64_tr_b16 a[2:3], v7 offset:1536
  v_mfma_f32_16x16x32_bf16 v[100:103], a[24:27], a[36:39], v[100:103]
  ds_read_b64_tr_b16 a[12:13], v7 offset:3072
  v_mfma_f32_16x16x32_bf16 v[104:107], a[28:31], a[36:39], v[104:107]
  ds_read_b64_tr_b16 a[14:15], v7 offset:4608
  v_mfma_f32_16x16x32_bf16 v[104:107], a[16:19], v[24:27], v[104:107]
  ds_read_b64_tr_b16 a[24:25], v7 offset:6144
  v_mfma_f32_16x16x32_bf16 v[104:107], a[4:7], v[20:23], v[104:107]
  ds_read_b64_tr_b16 a[26:27], v7 offset:7680
  v_mfma_f32_16x16x32_bf16 v[92:95], a[28:31], v[20:23], v[92:95]
  ds_read_b64_tr_b16 a[28:29], v7 offset:6152
  v_mfma_f32_16x16x32_bf16 v[92:95], a[16:19], v[16:19], v[92:95]
  ds_read_b64_tr_b16 a[30:31], v7 offset:7688
  ds_read_b128 a[56:59], v0 offset:26816
  v_mfma_f32_16x16x32_bf16 v[92:95], a[4:7], v[12:15], v[92:95]
  ds_read_b64_tr_b16 a[16:17], v7 offset:3080
  v_mfma_f32_16x16x32_bf16 v[96:99], a[8:11], v[12:15], v[96:99]
  ds_read_b64_tr_b16 a[18:19], v7 offset:4616
  v_mfma_f32_16x16x32_bf16 v[96:99], a[20:23], v[16:19], v[96:99]
  ds_read_b64_tr_b16 a[4:5], v7 offset:8
  v_mfma_f32_16x16x32_bf16 v[96:99], a[32:35], v[20:23], v[96:99]
  ds_read_b64_tr_b16 a[6:7], v7 offset:1544
  v_mfma_f32_16x16x32_bf16 v[108:111], a[8:11], v[20:23], v[108:111]
  ds_read_b64_tr_b16 a[8:9], v7 offset:16
  v_mfma_f32_16x16x32_bf16 v[108:111], a[20:23], v[24:27], v[108:111]
  ds_read_b64_tr_b16 a[10:11], v7 offset:1552
  v_mfma_f32_16x16x32_bf16 v[108:111], a[32:35], a[36:39], v[108:111]
  s_waitcnt lgkmcnt(6)
  ds_read_b64_tr_b16 a[20:21], v7 offset:3088
  v_mfma_f32_16x16x32_bf16 v[28:31], a[0:3], a[40:43], v[28:31]
  ds_read_b64_tr_b16 a[22:23], v7 offset:4624
  v_mfma_f32_16x16x32_bf16 v[28:31], a[12:15], a[48:51], v[28:31]
  ds_read_b64_tr_b16 a[32:33], v7 offset:6160
  v_mfma_f32_16x16x32_bf16 v[28:31], a[24:27], a[52:55], v[28:31]
  ds_read_b64_tr_b16 a[34:35], v7 offset:7696
  v_mfma_f32_16x16x32_bf16 v[40:43], a[0:3], a[52:55], v[40:43]
  ds_read_b128 v[12:15], v0 offset:27328
  ds_read_b128 v[16:19], v0 offset:27840
  v_mfma_f32_16x16x32_bf16 v[40:43], a[12:15], a[44:47], v[40:43]
  ds_read_b128 v[20:23], v0 offset:28352
  ds_read_b128 v[24:27], v0 offset:28864
  v_mfma_f32_16x16x32_bf16 v[40:43], a[24:27], a[56:59], v[40:43]
  s_waitcnt lgkmcnt(10)
  v_mfma_f32_16x16x32_bf16 v[44:47], a[28:31], a[56:59], v[44:47]
  v_mfma_f32_16x16x32_bf16 v[44:47], a[16:19], a[44:47], v[44:47]
  v_mfma_f32_16x16x32_bf16 v[44:47], a[4:7], a[52:55], v[44:47]
  v_mfma_f32_16x16x32_bf16 v[32:35], a[28:31], a[52:55], v[32:35]
  s_barrier
  v_mfma_f32_16x16x32_bf16 v[32:35], a[16:19], a[48:51], v[32:35]
  v_mfma_f32_16x16x32_bf16 v[32:35], a[4:7], a[40:43], v[32:35]
  s_waitcnt lgkmcnt(4)
  v_mfma_f32_16x16x32_bf16 v[36:39], a[8:11], a[40:43], v[36:39]
  v_mfma_f32_16x16x32_bf16 v[36:39], a[20:23], a[48:51], v[36:39]
  v_mfma_f32_16x16x32_bf16 v[36:39], a[32:35], a[52:55], v[36:39]
  v_mfma_f32_16x16x32_bf16 v[48:51], a[8:11], a[52:55], v[48:51]
  v_mfma_f32_16x16x32_bf16 v[48:51], a[20:23], a[44:47], v[48:51]
  v_mfma_f32_16x16x32_bf16 v[48:51], a[32:35], a[56:59], v[48:51]
  v_mfma_f32_16x16x32_bf16 v[52:55], a[0:3], a[56:59], v[52:55]
  s_waitcnt lgkmcnt(2)
  v_mfma_f32_16x16x32_bf16 v[52:55], a[12:15], v[12:15], v[52:55]
  v_mfma_f32_16x16x32_bf16 v[52:55], a[24:27], v[16:19], v[52:55]
  v_mfma_f32_16x16x32_bf16 v[56:59], a[28:31], v[16:19], v[56:59]
  v_mfma_f32_16x16x32_bf16 v[56:59], a[16:19], v[12:15], v[56:59]
  ds_read_b128 a[36:39], v0 offset:29376
  v_mfma_f32_16x16x32_bf16 v[56:59], a[4:7], a[56:59], v[56:59]
  ds_read_b128 a[40:43], v0 offset:29888
  v_mfma_f32_16x16x32_bf16 v[60:63], a[8:11], a[56:59], v[60:63]
  v_mfma_f32_16x16x32_bf16 v[60:63], a[20:23], v[12:15], v[60:63]
  v_mfma_f32_16x16x32_bf16 v[60:63], a[32:35], v[16:19], v[60:63]
  v_mfma_f32_16x16x32_bf16 v[64:67], a[0:3], v[16:19], v[64:67]
  s_waitcnt lgkmcnt(2)
  v_mfma_f32_16x16x32_bf16 v[64:67], a[12:15], v[20:23], v[64:67]
  v_mfma_f32_16x16x32_bf16 v[64:67], a[24:27], v[24:27], v[64:67]
  v_mfma_f32_16x16x32_bf16 v[68:71], a[28:31], v[24:27], v[68:71]
  v_mfma_f32_16x16x32_bf16 v[68:71], a[16:19], v[20:23], v[68:71]
  ds_read_b128 a[48:51], v0 offset:30400
  v_mfma_f32_16x16x32_bf16 v[68:71], a[4:7], v[16:19], v[68:71]
  ds_read_b128 a[52:55], v0 offset:30912
  v_mfma_f32_16x16x32_bf16 v[72:75], a[8:11], v[16:19], v[72:75]
  ds_read_b128 a[44:47], v0 offset:31424
  v_mfma_f32_16x16x32_bf16 v[72:75], a[20:23], v[20:23], v[72:75]
  ds_read_b128 a[56:59], v0 offset:31936
  v_mfma_f32_16x16x32_bf16 v[72:75], a[32:35], v[24:27], v[72:75]
  v_mfma_f32_16x16x32_bf16 v[76:79], a[0:3], v[24:27], v[76:79]
  s_waitcnt lgkmcnt(4)
  v_mfma_f32_16x16x32_bf16 v[76:79], a[12:15], a[36:39], v[76:79]
  v_mfma_f32_16x16x32_bf16 v[76:79], a[24:27], a[40:43], v[76:79]
  v_mfma_f32_16x16x32_bf16 v[80:83], a[28:31], a[40:43], v[80:83]
  v_mfma_f32_16x16x32_bf16 v[80:83], a[16:19], a[36:39], v[80:83]
  v_mfma_f32_16x16x32_bf16 v[80:83], a[4:7], v[24:27], v[80:83]
  v_mfma_f32_16x16x32_bf16 v[84:87], a[8:11], v[24:27], v[84:87]
  s_barrier
  v_mfma_f32_16x16x32_bf16 v[84:87], a[20:23], a[36:39], v[84:87]
  ds_read_b128 v[12:15], v0 offset:0
  v_mfma_f32_16x16x32_bf16 v[84:87], a[32:35], a[40:43], v[84:87]
  ds_read_b128 v[16:19], v0 offset:512
  v_mfma_f32_16x16x32_bf16 v[88:91], a[0:3], a[40:43], v[88:91]
  s_waitcnt lgkmcnt(2)
  v_mfma_f32_16x16x32_bf16 v[88:91], a[12:15], a[48:51], v[88:91]
  ds_read_b128 v[20:23], v0 offset:1024
  v_mfma_f32_16x16x32_bf16 v[88:91], a[24:27], a[52:55], v[88:91]
  ds_read_b128 v[24:27], v0 offset:1536
  v_mfma_f32_16x16x32_bf16 v[100:103], a[0:3], a[52:55], v[100:103]
  ds_read_b64_tr_b16 a[0:1], v6 offset:36864
  v_mfma_f32_16x16x32_bf16 v[100:103], a[12:15], a[44:47], v[100:103]
  ds_read_b64_tr_b16 a[2:3], v6 offset:38400
  v_mfma_f32_16x16x32_bf16 v[100:103], a[24:27], a[56:59], v[100:103]
  ds_read_b64_tr_b16 a[12:13], v6 offset:39936
  v_mfma_f32_16x16x32_bf16 v[104:107], a[28:31], a[56:59], v[104:107]
  ds_read_b64_tr_b16 a[14:15], v6 offset:41472
  v_mfma_f32_16x16x32_bf16 v[104:107], a[16:19], a[44:47], v[104:107]
  ds_read_b64_tr_b16 a[24:25], v6 offset:43008
  v_mfma_f32_16x16x32_bf16 v[104:107], a[4:7], a[52:55], v[104:107]
  ds_read_b64_tr_b16 a[26:27], v6 offset:44544
L_pg3:
  s_cmp_lg_u32 s32, 0
  s_cbranch_scc1 L_pr3
  v_mfma_f32_16x16x32_bf16 v[92:95], a[28:31], a[52:55], v[92:95]
  ds_read_b64_tr_b16 a[28:29], v6 offset:43016
  v_mfma_f32_16x16x32_bf16 v[92:95], a[16:19], a[48:51], v[92:95]
  ds_read_b64_tr_b16 a[30:31], v6 offset:44552
  ds_read_b128 a[36:39], v0 offset:2048
  v_mfma_f32_16x16x32_bf16 v[92:95], a[4:7], a[40:43], v[92:95]
  ds_read_b64_tr_b16 a[16:17], v6 offset:39944
  v_mfma_f32_16x16x32_bf16 v[96:99], a[8:11], a[40:43], v[96:99]
  ds_read_b64_tr_b16 a[18:19], v6 offset:41480
  v_mfma_f32_16x16x32_bf16 v[96:99], a[20:23], a[48:51], v[96:99]
  ds_read_b64_tr_b16 a[4:5], v6 offset:36872
  v_mfma_f32_16x16x32_bf16 v[96:99], a[32:35], a[52:55], v[96:99]
  ds_read_b64_tr_b16 a[6:7], v6 offset:38408
  v_mfma_f32_16x16x32_bf16 v[108:111], a[8:11], a[52:55], v[108:111]
  ds_read_b64_tr_b16 a[8:9], v6 offset:36880
  v_mfma_f32_16x16x32_bf16 v[108:111], a[20:23], a[44:47], v[108:111]
  ds_read_b64_tr_b16 a[10:11], v6 offset:38416
  v_mfma_f32_16x16x32_bf16 v[108:111], a[32:35], a[56:59], v[108:111]
  s_waitcnt lgkmcnt(6)
  ds_read_b64_tr_b16 a[20:21], v6 offset:39952
  v_mfma_f32_16x16x32_bf16 v[112:115], a[0:3], v[12:15], v[112:115]
  ds_read_b64_tr_b16 a[22:23], v6 offset:41488
  v_mfma_f32_16x16x32_bf16 v[112:115], a[12:15], v[16:19], v[112:115]
  ds_read_b64_tr_b16 a[32:33], v6 offset:43024
  v_mfma_f32_16x16x32_bf16 v[112:115], a[24:27], v[20:23], v[112:115]
  ds_read_b64_tr_b16 a[34:35], v6 offset:44560
  v_mfma_f32_16x16x32_bf16 v[124:127], a[0:3], v[20:23], v[124:127]
  v_mfma_f32_16x16x32_bf16 v[124:127], a[12:15], v[24:27], v[124:127]
  ds_read_b128 a[40:43], v0 offset:2560
  v_mfma_f32_16x16x32_bf16 v[124:127], a[24:27], a[36:39], v[124:127]
  s_waitcnt lgkmcnt(7)
  v_mfma_f32_16x16x32_bf16 v[128:131], a[28:31], a[36:39], v[128:131]
  ds_read_b128 a[48:51], v0 offset:3072
  v_mfma_f32_16x16x32_bf16 v[128:131], a[16:19], v[24:27], v[128:131]
  v_mfma_f32_16x16x32_bf16 v[128:131], a[4:7], v[20:23], v[128:131]
  v_mfma_f32_16x16x32_bf16 v[116:119], a[28:31], v[20:23], v[116:119]
  v_lshlrev_b32 v9, 16, v2
  v_fma_f32 v28, v28, 0.5, v9
  v_mfma_f32_16x16x32_bf16 v[116:119], a[16:19], v[16:19], v[116:119]
  v_fma_f32 v40, v40, 0.5, v9
  v_fma_f32 v52, v52, 0.5, v9
  v_mfma_f32_16x16x32_bf16 v[116:119], a[4:7], v[12:15], v[116:119]
  s_waitcnt lgkmcnt(2)
  v_fma_f32 v64, v64, 0.5, v9
  v_mfma_f32_16x16x32_bf16 v[120:123], a[8:11], v[12:15], v[120:123]
  v_fma_f32 v76, v76, 0.5, v9
  v_fma_f32 v88, v88, 0.5, v9
  v_mfma_f32_16x16x32_bf16 v[120:123], a[20:23], v[16:19], v[120:123]
  ds_read_b128 a[52:55], v0 offset:3584
  v_fma_f32 v100, v100, 0.5, v9
  v_mfma_f32_16x16x32_bf16 v[120:123], a[32:35], v[20:23], v[120:123]
  ds_read_b128 a[44:47], v0 offset:4096
  v_and_b32 v9, 0xffff0000, v2
  v_mfma_f32_16x16x32_bf16 v[132:135], a[8:11], v[20:23], v[132:135]
  v_fma_f32 v29, v29, 0.5, v9
  v_fma_f32 v41, v41, 0.5, v9
  v_mfma_f32_16x16x32_bf16 v[132:135], a[20:23], v[24:27], v[132:135]
  v_fma_f32 v53, v53, 0.5, v9
  v_fma_f32 v65, v65, 0.5, v9
  v_mfma_f32_16x16x32_bf16 v[132:135], a[32:35], a[36:39], v[132:135]
  v_fma_f32 v77, v77, 0.5, v9
  v_fma_f32 v89, v89, 0.5, v9
  v_mfma_f32_16x16x32_bf16 v[136:139], a[0:3], a[36:39], v[136:139]
  s_waitcnt lgkmcnt(2)
  v_fma_f32 v101, v101, 0.5, v9
  v_mfma_f32_16x16x32_bf16 v[136:139], a[12:15], a[40:43], v[136:139]
  v_lshlrev_b32 v9, 16, v3
  v_fma_f32 v30, v30, 0.5, v9
  v_mfma_f32_16x16x32_bf16 v[136:139], a[24:27], a[48:51], v[136:139]
  v_fma_f32 v42, v42, 0.5, v9
  v_fma_f32 v54, v54, 0.5, v9
  v_mfma_f32_16x16x32_bf16 v[140:143], a[28:31], a[48:51], v[140:143]
  v_fma_f32 v66, v66, 0.5, v9
  v_fma_f32 v78, v78, 0.5, v9
  v_mfma_f32_16x16x32_bf16 v[140:143], a[16:19], a[40:43], v[140:143]
  ds_read_b128 a[56:59], v0 offset:4608
  v_fma_f32 v90, v90, 0.5, v9
  v_mfma_f32_16x16x32_bf16 v[140:143], a[4:7], a[36:39], v[140:143]
  ds_read_b128 v[12:15], v0 offset:5120
  v_fma_f32 v102, v102, 0.5, v9
  v_mfma_f32_16x16x32_bf16 v[144:147], a[8:11], a[36:39], v[144:147]
  v_and_b32 v9, 0xffff0000, v3
  v_fma_f32 v31, v31, 0.5, v9
  v_mfma_f32_16x16x32_bf16 v[144:147], a[20:23], a[40:43], v[144:147]
  v_fma_f32 v43, v43, 0.5, v9
  v_fma_f32 v55, v55, 0.5, v9
  v_mfma_f32_16x16x32_bf16 v[144:147], a[32:35], a[48:51], v[144:147]
  v_fma_f32 v67, v67, 0.5, v9
  v_fma_f32 v79, v79, 0.5, v9
  v_mfma_f32_16x16x32_bf16 v[148:151], a[0:3], a[48:51], v[148:151]
  s_waitcnt lgkmcnt(2)
  v_fma_f32 v91, v91, 0.5, v9
  v_mfma_f32_16x16x32_bf16 v[148:151], a[12:15], a[52:55], v[148:151]
  v_fma_f32 v103, v103, 0.5, v9
  v_lshlrev_b32 v9, 16, v4
  v_mfma_f32_16x16x32_bf16 v[148:151], a[24:27], a[44:47], v[148:151]
  v_fma_f32 v32, v32, 0.5, v9
  v_fma_f32 v44, v44, 0.5, v9
  v_mfma_f32_16x16x32_bf16 v[152:155], a[28:31], a[44:47], v[152:155]
  v_fma_f32 v56, v56, 0.5, v9
  v_fma_f32 v68, v68, 0.5, v9
  v_mfma_f32_16x16x32_bf16 v[152:155], a[16:19], a[52:55], v[152:155]
  ds_read_b128 v[16:19], v0 offset:5632
  v_fma_f32 v80, v80, 0.5, v9
  v_mfma_f32_16x16x32_bf16 v[152:155], a[4:7], a[48:51], v[152:155]
  ds_read_b128 v[20:23], v0 offset:6144
  v_fma_f32 v92, v92, 0.5, v9
  v_mfma_f32_16x16x32_bf16 v[156:159], a[8:11], a[48:51], v[156:159]
  ds_read_b128 v[24:27], v0 offset:6656
  v_fma_f32 v104, v104, 0.5, v9
  v_mfma_f32_16x16x32_bf16 v[156:159], a[20:23], a[52:55], v[156:159]
  ds_read_b128 a[36:39], v0 offset:7168
  v_and_b32 v9, 0xffff0000, v4
  v_mfma_f32_16x16x32_bf16 v[156:159], a[32:35], a[44:47], v[156:159]
  v_fma_f32 v33, v33, 0.5, v9
  v_fma_f32 v45, v45, 0.5, v9
  v_mfma_f32_16x16x32_bf16 v[160:163], a[0:3], a[44:47], v[160:163]
  s_waitcnt lgkmcnt(4)
  v_fma_f32 v57, v57, 0.5, v9
  v_mfma_f32_16x16x32_bf16 v[160:163], a[12:15], a[56:59], v[160:163]
  v_fma_f32 v69, v69, 0.5, v9
  v_fma_f32 v81, v81, 0.5, v9
  v_mfma_f32_16x16x32_bf16 v[160:163], a[24:27], v[12:15], v[160:163]
  v_fma_f32 v93, v93, 0.5, v9
  v_fma_f32 v105, v105, 0.5, v9
  v_mfma_f32_16x16x32_bf16 v[164:167], a[28:31], v[12:15], v[164:167]
  v_lshlrev_b32 v9, 16, v5
  v_fma_f32 v34, v34, 0.5, v9
  v_mfma_f32_16x16x32_bf16 v[164:167], a[16:19], a[56:59], v[164:167]
  v_fma_f32 v46, v46, 0.5, v9
  v_fma_f32 v58, v58, 0.5, v9
  v_mfma_f32_16x16x32_bf16 v[164:167], a[4:7], a[44:47], v[164:167]
  v_fma_f32 v70, v70, 0.5, v9
  v_fma_f32 v82, v82, 0.5, v9
  v_mfma_f32_16x16x32_bf16 v[168:171], a[8:11], a[44:47], v[168:171]
  s_barrier
  v_fma_f32 v94, v94, 0.5, v9
  v_mfma_f32_16x16x32_bf16 v[168:171], a[20:23], a[56:59], v[168:171]
  ds_read_b128 a[40:43], v0 offset:8256
  v_fma_f32 v106, v106, 0.5, v9
  v_mfma_f32_16x16x32_bf16 v[168:171], a[32:35], v[12:15], v[168:171]
  ds_read_b128 a[48:51], v0 offset:8768
  v_and_b32 v9, 0xffff0000, v5
  v_mfma_f32_16x16x32_bf16 v[172:175], a[0:3], v[12:15], v[172:175]
  s_waitcnt lgkmcnt(2)
  v_fma_f32 v35, v35, 0.5, v9
  v_mfma_f32_16x16x32_bf16 v[172:175], a[12:15], v[16:19], v[172:175]
  ds_read_b128 a[52:55], v0 offset:9280
  v_fma_f32 v47, v47, 0.5, v9
  v_mfma_f32_16x16x32_bf16 v[172:175], a[24:27], v[20:23], v[172:175]
  ds_read_b128 a[44:47], v0 offset:9792
  v_fma_f32 v59, v59, 0.5, v9
  v_mfma_f32_16x16x32_bf16 v[184:187], a[0:3], v[20:23], v[184:187]
  ds_read_b64_tr_b16 a[0:1], v6 offset:0
  v_fma_f32 v71, v71, 0.5, v9
  v_mfma_f32_16x16x32_bf16 v[184:187], a[12:15], v[24:27], v[184:187]
  ds_read_b64_tr_b16 a[2:3], v6 offset:1536
  v_fma_f32 v83, v83, 0.5, v9
  v_mfma_f32_16x16x32_bf16 v[184:187], a[24:27], a[36:39], v[184:187]
  ds_read_b64_tr_b16 a[12:13], v6 offset:3072
  v_fma_f32 v95, v95, 0.5, v9
  v_mfma_f32_16x16x32_bf16 v[188:191], a[28:31], a[36:39], v[188:191]
  ds_read_b64_tr_b16 a[14:15], v6 offset:4608
  v_fma_f32 v107, v107, 0.5, v9
  v_mfma_f32_16x16x32_bf16 v[188:191], a[16:19], v[24:27], v[188:191]
  ds_read_b64_tr_b16 a[24:25], v6 offset:6144
  v_lshlrev_b32 v9, 16, v10
  v_mfma_f32_16x16x32_bf16 v[188:191], a[4:7], v[20:23], v[188:191]
  ds_read_b64_tr_b16 a[26:27], v6 offset:7680
  v_fma_f32 v36, v36, 0.5, v9
  v_mfma_f32_16x16x32_bf16 v[176:179], a[28:31], v[20:23], v[176:179]
  ds_read_b64_tr_b16 a[28:29], v6 offset:6152
  v_fma_f32 v48, v48, 0.5, v9
  v_mfma_f32_16x16x32_bf16 v[176:179], a[16:19], v[16:19], v[176:179]
  ds_read_b64_tr_b16 a[30:31], v6 offset:7688
  ds_read_b128 a[56:59], v0 offset:10304
  v_mfma_f32_16x16x32_bf16 v[176:179], a[4:7], v[12:15], v[176:179]
  ds_read_b64_tr_b16 a[16:17], v6 offset:3080
  v_fma_f32 v60, v60, 0.5, v9
  v_mfma_f32_16x16x32_bf16 v[180:183], a[8:11], v[12:15], v[180:183]
  ds_read_b64_tr_b16 a[18:19], v6 offset:4616
  v_fma_f32 v72, v72, 0.5, v9
  v_mfma_f32_16x16x32_bf16 v[180:183], a[20:23], v[16:19], v[180:183]
  ds_read_b64_tr_b16 a[4:5], v6 offset:8
  v_fma_f32 v84, v84, 0.5, v9
  v_mfma_f32_16x16x32_bf16 v[180:183], a[32:35], v[20:23], v[180:183]
  ds_read_b64_tr_b16 a[6:7], v6 offset:1544
  v_fma_f32 v96, v96, 0.5, v9
  v_mfma_f32_16x16x32_bf16 v[192:195], a[8:11], v[20:23], v[192:195]
  ds_read_b64_tr_b16 a[8:9], v6 offset:16
  v_fma_f32 v108, v108, 0.5, v9
  v_mfma_f32_16x16x32_bf16 v[192:195], a[20:23], v[24:27], v[192:195]
  ds_read_b64_tr_b16 a[10:11], v6 offset:1552
  v_and_b32 v9, 0xffff0000, v10
  v_mfma_f32_16x16x32_bf16 v[192:195], a[32:35], a[36:39], v[192:195]
  s_waitcnt lgkmcnt(6)
  ds_read_b64_tr_b16 a[20:21], v6 offset:3088
  v_mfma_f32_16x16x32_bf16 v[112:115], a[0:3], a[40:43], v[112:115]
  ds_read_b64_tr_b16 a[22:23], v6 offset:4624
  v_fma_f32 v37, v37, 0.5, v9
  v_mfma_f32_16x16x32_bf16 v[112:115], a[12:15], a[48:51], v[112:115]
  ds_read_b64_tr_b16 a[32:33], v6 offset:6160
  v_fma_f32 v49, v49, 0.5, v9
  v_mfma_f32_16x16x32_bf16 v[112:115], a[24:27], a[52:55], v[112:115]
  ds_read_b64_tr_b16 a[34:35], v6 offset:7696
  v_fma_f32 v61, v61, 0.5, v9
  v_mfma_f32_16x16x32_bf16 v[124:127], a[0:3], a[52:55], v[124:127]
  ds_read_b128 v[12:15], v0 offset:10816
  ds_read_b128 v[16:19], v0 offset:11328
  v_mfma_f32_16x16x32_bf16 v[124:127], a[12:15], a[44:47], v[124:127]
  ds_read_b128 v[20:23], v0 offset:11840
  ds_read_b128 v[24:27], v0 offset:12352
  v_mfma_f32_16x16x32_bf16 v[124:127], a[24:27], a[56:59], v[124:127]
  s_waitcnt lgkmcnt(10)
  v_fma_f32 v73, v73, 0.5, v9
  v_mfma_f32_16x16x32_bf16 v[128:131], a[28:31], a[56:59], v[128:131]
  v_fma_f32 v85, v85, 0.5, v9
  v_fma_f32 v97, v97, 0.5, v9
  v_mfma_f32_16x16x32_bf16 v[128:131], a[16:19], a[44:47], v[128:131]
  v_fma_f32 v109, v109, 0.5, v9
  v_lshlrev_b32 v9, 16, v11
  v_mfma_f32_16x16x32_bf16 v[128:131], a[4:7], a[52:55], v[128:131]
  v_fma_f32 v38, v38, 0.5, v9
  v_fma_f32 v50, v50, 0.5, v9
  v_mfma_f32_16x16x32_bf16 v[116:119], a[28:31], a[52:55], v[116:119]
  s_barrier
  v_fma_f32 v62, v62, 0.5, v9
  v_mfma_f32_16x16x32_bf16 v[116:119], a[16:19], a[48:51], v[116:119]
  v_fma_f32 v74, v74, 0.5, v9
  v_fma_f32 v86, v86, 0.5, v9
  v_mfma_f32_16x16x32_bf16 v[116:119], a[4:7], a[40:43], v[116:119]
  s_waitcnt lgkmcnt(4)
  v_fma_f32 v98, v98, 0.5, v9
  v_mfma_f32_16x16x32_bf16 v[120:123], a[8:11], a[40:43], v[120:123]
  v_fma_f32 v110, v110, 0.5, v9
  v_and_b32 v9, 0xffff0000, v11
  v_mfma_f32_16x16x32_bf16 v[120:123], a[20:23], a[48:51], v[120:123]
  v_fma_f32 v39, v39, 0.5, v9
  v_fma_f32 v51, v51, 0.5, v9
  v_mfma_f32_16x16x32_bf16 v[120:123], a[32:35], a[52:55], v[120:123]
  v_fma_f32 v63, v63, 0.5, v9
  v_fma_f32 v75, v75, 0.5, v9
  v_mfma_f32_16x16x32_bf16 v[132:135], a[8:11], a[52:55], v[132:135]
  v_fma_f32 v87, v87, 0.5, v9
  v_fma_f32 v99, v99, 0.5, v9
  v_mfma_f32_16x16x32_bf16 v[132:135], a[20:23], a[44:47], v[132:135]
  v_fma_f32 v111, v111, 0.5, v9
  v_fmac_f32 v28, 0.5, v112
  v_mfma_f32_16x16x32_bf16 v[132:135], a[32:35], a[56:59], v[132:135]
  v_sub_f32 v112, v28, v112
  v_fmac_f32 v29, 0.5, v113
  v_mfma_f32_16x16x32_bf16 v[136:139], a[0:3], a[56:59], v[136:139]
  s_waitcnt lgkmcnt(2)
  v_sub_f32 v113, v29, v113
  v_mfma_f32_16x16x32_bf16 v[136:139], a[12:15], v[12:15], v[136:139]
  v_fmac_f32 v30, 0.5, v114
  v_sub_f32 v114, v30, v114
  v_mfma_f32_16x16x32_bf16 v[136:139], a[24:27], v[16:19], v[136:139]
  v_fmac_f32 v31, 0.5, v115
  v_sub_f32 v115, v31, v115
  v_mfma_f32_16x16x32_bf16 v[140:143], a[28:31], v[16:19], v[140:143]
  v_fmac_f32 v40, 0.5, v124
  v_sub_f32 v124, v40, v124
  v_mfma_f32_16x16x32_bf16 v[140:143], a[16:19], v[12:15], v[140:143]
  ds_read_b128 a[36:39], v0 offset:12864
  v_fmac_f32 v41, 0.5, v125
  v_mfma_f32_16x16x32_bf16 v[140:143], a[4:7], a[56:59], v[140:143]
  ds_read_b128 a[40:43], v0 offset:13376
  v_sub_f32 v125, v41, v125
  v_mfma_f32_16x16x32_bf16 v[144:147], a[8:11], a[56:59], v[144:147]
  v_fmac_f32 v42, 0.5, v126
  v_sub_f32 v126, v42, v126
  v_mfma_f32_16x16x32_bf16 v[144:147], a[20:23], v[12:15], v[144:147]
  v_fmac_f32 v43, 0.5, v127
  v_sub_f32 v127, v43, v127
  v_mfma_f32_16x16x32_bf16 v[144:147], a[32:35], v[16:19], v[144:147]
  v_fmac_f32 v44, 0.5, v128
  v_sub_f32 v128, v44, v128
  v_mfma_f32_16x16x32_bf16 v[148:151], a[0:3], v[16:19], v[148:151]
  s_waitcnt lgkmcnt(2)
  v_fmac_f32 v45, 0.5, v129
  v_mfma_f32_16x16x32_bf16 v[148:151], a[12:15], v[20:23], v[148:151]
  v_sub_f32 v129, v45, v129
  v_fmac_f32 v46, 0.5, v130
  v_mfma_f32_16x16x32_bf16 v[148:151], a[24:27], v[24:27], v[148:151]
  v_sub_f32 v130, v46, v130
  v_fmac_f32 v47, 0.5, v131
  v_mfma_f32_16x16x32_bf16 v[152:155], a[28:31], v[24:27], v[152:155]
  v_sub_f32 v131, v47, v131
  v_fmac_f32 v32, 0.5, v116
  v_mfma_f32_16x16x32_bf16 v[152:155], a[16:19], v[20:23], v[152:155]
  ds_read_b128 a[48:51], v0 offset:13888
  v_sub_f32 v116, v32, v116
  v_mfma_f32_16x16x32_bf16 v[152:155], a[4:7], v[16:19], v[152:155]
  ds_read_b128 a[52:55], v0 offset:14400
  v_fmac_f32 v33, 0.5, v117
  v_mfma_f32_16x16x32_bf16 v[156:159], a[8:11], v[16:19], v[156:159]
  ds_read_b128 a[44:47], v0 offset:14912
  v_sub_f32 v117, v33, v117
  v_mfma_f32_16x16x32_bf16 v[156:159], a[20:23], v[20:23], v[156:159]
  ds_read_b128 a[56:59], v0 offset:15424
  v_fmac_f32 v34, 0.5, v118
  v_mfma_f32_16x16x32_bf16 v[156:159], a[32:35], v[24:27], v[156:159]
  v_sub_f32 v118, v34, v118
  v_fmac_f32 v35, 0.5, v119
  v_mfma_f32_16x16x32_bf16 v[160:163], a[0:3], v[24:27], v[160:163]
  s_waitcnt lgkmcnt(4)
  v_sub_f32 v119, v35, v119
  v_mfma_f32_16x16x32_bf16 v[160:163], a[12:15], a[36:39], v[160:163]
  v_fmac_f32 v36, 0.5, v120
  v_sub_f32 v120, v36, v120
  v_mfma_f32_16x16x32_bf16 v[160:163], a[24:27], a[40:43], v[160:163]
  v_fmac_f32 v37, 0.5, v121
  v_sub_f32 v121, v37, v121
  v_mfma_f32_16x16x32_bf16 v[164:167], a[28:31], a[40:43], v[164:167]
  v_fmac_f32 v38, 0.5, v122
  v_sub_f32 v122, v38, v122
  v_mfma_f32_16x16x32_bf16 v[164:167], a[16:19], a[36:39], v[164:167]
  v_fmac_f32 v39, 0.5, v123
  v_sub_f32 v123, v39, v123
  v_mfma_f32_16x16x32_bf16 v[164:167], a[4:7], v[24:27], v[164:167]
  v_fmac_f32 v48, 0.5, v132
  v_sub_f32 v132, v48, v132
  v_mfma_f32_16x16x32_bf16 v[168:171], a[8:11], v[24:27], v[168:171]
  s_barrier
  v_fmac_f32 v49, 0.5, v133
  v_mfma_f32_16x16x32_bf16 v[168:171], a[20:23], a[36:39], v[168:171]
  ds_read_b128 v[12:15], v0 offset:16512
  v_sub_f32 v133, v49, v133
  v_mfma_f32_16x16x32_bf16 v[168:171], a[32:35], a[40:43], v[168:171]
  ds_read_b128 v[16:19], v0 offset:17024
  v_fmac_f32 v50, 0.5, v134
  v_mfma_f32_16x16x32_bf16 v[172:175], a[0:3], a[40:43], v[172:175]
  s_waitcnt lgkmcnt(2)
  v_sub_f32 v134, v50, v134
  v_mfma_f32_16x16x32_bf16 v[172:175], a[12:15], a[48:51], v[172:175]
  ds_read_b128 v[20:23], v0 offset:17536
  v_fmac_f32 v51, 0.5, v135
  v_mfma_f32_16x16x32_bf16 v[172:175], a[24:27], a[52:55], v[172:175]
  ds_read_b128 v[24:27], v0 offset:18048
  v_sub_f32 v135, v51, v135
  v_mfma_f32_16x16x32_bf16 v[184:187], a[0:3], a[52:55], v[184:187]
  ds_read_b64_tr_b16 a[0:1], v7 offset:0
  v_fmac_f32 v52, 0.5, v136
  v_mfma_f32_16x16x32_bf16 v[184:187], a[12:15], a[44:47], v[184:187]
  ds_read_b64_tr_b16 a[2:3], v7 offset:1536
  v_sub_f32 v136, v52, v136
  v_mfma_f32_16x16x32_bf16 v[184:187], a[24:27], a[56:59], v[184:187]
  ds_read_b64_tr_b16 a[12:13], v7 offset:3072
  v_fmac_f32 v53, 0.5, v137
  v_mfma_f32_16x16x32_bf16 v[188:191], a[28:31], a[56:59], v[188:191]
  ds_read_b64_tr_b16 a[14:15], v7 offset:4608
  v_sub_f32 v137, v53, v137
  v_mfma_f32_16x16x32_bf16 v[188:191], a[16:19], a[44:47], v[188:191]
  ds_read_b64_tr_b16 a[24:25], v7 offset:6144
  v_fmac_f32 v54, 0.5, v138
  v_mfma_f32_16x16x32_bf16 v[188:191], a[4:7], a[52:55], v[188:191]
  ds_read_b64_tr_b16 a[26:27], v7 offset:7680
  v_sub_f32 v138, v54, v138
  v_mfma_f32_16x16x32_bf16 v[176:179], a[28:31], a[52:55], v[176:179]
  ds_read_b64_tr_b16 a[28:29], v7 offset:6152
  v_fmac_f32 v55, 0.5, v139
  v_mfma_f32_16x16x32_bf16 v[176:179], a[16:19], a[48:51], v[176:179]
  ds_read_b64_tr_b16 a[30:31], v7 offset:7688
  ds_read_b128 a[36:39], v0 offset:18560
  v_mfma_f32_16x16x32_bf16 v[176:179], a[4:7], a[40:43], v[176:179]
  ds_read_b64_tr_b16 a[16:17], v7 offset:3080
  v_sub_f32 v139, v55, v139
  v_mfma_f32_16x16x32_bf16 v[180:183], a[8:11], a[40:43], v[180:183]
  ds_read_b64_tr_b16 a[18:19], v7 offset:4616
  v_fmac_f32 v56, 0.5, v140
  v_mfma_f32_16x16x32_bf16 v[180:183], a[20:23], a[48:51], v[180:183]
  ds_read_b64_tr_b16 a[4:5], v7 offset:8
  v_sub_f32 v140, v56, v140
  v_mfma_f32_16x16x32_bf16 v[180:183], a[32:35], a[52:55], v[180:183]
  ds_read_b64_tr_b16 a[6:7], v7 offset:1544
  v_fmac_f32 v57, 0.5, v141
  v_mfma_f32_16x16x32_bf16 v[192:195], a[8:11], a[52:55], v[192:195]
  ds_read_b64_tr_b16 a[8:9], v7 offset:16
  v_sub_f32 v141, v57, v141
  v_mfma_f32_16x16x32_bf16 v[192:195], a[20:23], a[44:47], v[192:195]
  ds_read_b64_tr_b16 a[10:11], v7 offset:1552
  v_fmac_f32 v58, 0.5, v142
  v_mfma_f32_16x16x32_bf16 v[192:195], a[32:35], a[56:59], v[192:195]
  s_waitcnt lgkmcnt(6)
  ds_read_b64_tr_b16 a[20:21], v7 offset:3088
  v_mfma_f32_16x16x32_bf16 v[112:115], a[0:3], v[12:15], v[112:115]
  ds_read_b64_tr_b16 a[22:23], v7 offset:4624
  v_sub_f32 v142, v58, v142
  v_mfma_f32_16x16x32_bf16 v[112:115], a[12:15], v[16:19], v[112:115]
  ds_read_b64_tr_b16 a[32:33], v7 offset:6160
  v_fmac_f32 v59, 0.5, v143
  v_mfma_f32_16x16x32_bf16 v[112:115], a[24:27], v[20:23], v[112:115]
  ds_read_b64_tr_b16 a[34:35], v7 offset:7696
  v_sub_f32 v143, v59, v143
  v_mfma_f32_16x16x32_bf16 v[124:127], a[0:3], v[20:23], v[124:127]
  v_fmac_f32 v60, 0.5, v144
  v_sub_f32 v144, v60, v144
  v_mfma_f32_16x16x32_bf16 v[124:127], a[12:15], v[24:27], v[124:127]
  ds_read_b128 a[40:43], v0 offset:19072
  v_fmac_f32 v61, 0.5, v145
  v_mfma_f32_16x16x32_bf16 v[124:127], a[24:27], a[36:39], v[124:127]
  s_waitcnt lgkmcnt(7)
  v_sub_f32 v145, v61, v145
  v_mfma_f32_16x16x32_bf16 v[128:131], a[28:31], a[36:39], v[128:131]
  ds_read_b128 a[48:51], v0 offset:19584
  v_fmac_f32 v62, 0.5, v146
  v_mfma_f32_16x16x32_bf16 v[128:131], a[16:19], v[24:27], v[128:131]
  v_sub_f32 v146, v62, v146
  v_fmac_f32 v63, 0.5, v147
  v_mfma_f32_16x16x32_bf16 v[128:131], a[4:7], v[20:23], v[128:131]
  v_sub_f32 v147, v63, v147
  v_fmac_f32 v64, 0.5, v148
  v_mfma_f32_16x16x32_bf16 v[116:119], a[28:31], v[20:23], v[116:119]
  v_sub_f32 v148, v64, v148
  v_fmac_f32 v65, 0.5, v149
  v_mfma_f32_16x16x32_bf16 v[116:119], a[16:19], v[16:19], v[116:119]
  v_sub_f32 v149, v65, v149
  v_fmac_f32 v66, 0.5, v150
  v_mfma_f32_16x16x32_bf16 v[116:119], a[4:7], v[12:15], v[116:119]
  s_waitcnt lgkmcnt(2)
  v_sub_f32 v150, v66, v150
  v_mfma_f32_16x16x32_bf16 v[120:123], a[8:11], v[12:15], v[120:123]
  v_fmac_f32 v67, 0.5, v151
  v_sub_f32 v151, v67, v151
  v_mfma_f32_16x16x32_bf16 v[120:123], a[20:23], v[16:19], v[120:123]
  ds_read_b128 a[52:55], v0 offset:20096
  v_fmac_f32 v68, 0.5, v152
  v_mfma_f32_16x16x32_bf16 v[120:123], a[32:35], v[20:23], v[120:123]
  ds_read_b128 a[44:47], v0 offset:20608
  v_sub_f32 v152, v68, v152
  v_mfma_f32_16x16x32_bf16 v[132:135], a[8:11], v[20:23], v[132:135]
  v_fmac_f32 v69, 0.5, v153
  v_sub_f32 v153, v69, v153
  v_mfma_f32_16x16x32_bf16 v[132:135], a[20:23], v[24:27], v[132:135]
  v_fmac_f32 v70, 0.5, v154
  v_sub_f32 v154, v70, v154
  v_mfma_f32_16x16x32_bf16 v[132:135], a[32:35], a[36:39], v[132:135]
  v_fmac_f32 v71, 0.5, v155
  v_sub_f32 v155, v71, v155
  v_mfma_f32_16x16x32_bf16 v[136:139], a[0:3], a[36:39], v[136:139]
  s_waitcnt lgkmcnt(2)
  v_fmac_f32 v72, 0.5, v156
  v_mfma_f32_16x16x32_bf16 v[136:139], a[12:15], a[40:43], v[136:139]
  v_sub_f32 v156, v72, v156
  v_fmac_f32 v73, 0.5, v157
  v_mfma_f32_16x16x32_bf16 v[136:139], a[24:27], a[48:51], v[136:139]
  v_sub_f32 v157, v73, v157
  v_fmac_f32 v74, 0.5, v158
  v_mfma_f32_16x16x32_bf16 v[140:143], a[28:31], a[48:51], v[140:143]
  v_sub_f32 v158, v74, v158
  v_fmac_f32 v75, 0.5, v159
  v_mfma_f32_16x16x32_bf16 v[140:143], a[16:19], a[40:43], v[140:143]
  ds_read_b128 a[56:59], v0 offset:21120
  v_sub_f32 v159, v75, v159
  v_mfma_f32_16x16x32_bf16 v[140:143], a[4:7], a[36:39], v[140:143]
  ds_read_b128 v[12:15], v0 offset:21632
  v_fmac_f32 v76, 0.5, v160
  v_mfma_f32_16x16x32_bf16 v[144:147], a[8:11], a[36:39], v[144:147]
  v_sub_f32 v160, v76, v160
  v_fmac_f32 v77, 0.5, v161
  v_mfma_f32_16x16x32_bf16 v[144:147], a[20:23], a[40:43], v[144:147]
  v_sub_f32 v161, v77, v161
  v_fmac_f32 v78, 0.5, v162
  v_mfma_f32_16x16x32_bf16 v[144:147], a[32:35], a[48:51], v[144:147]
  v_sub_f32 v162, v78, v162
  v_fmac_f32 v79, 0.5, v163
  v_mfma_f32_16x16x32_bf16 v[148:151], a[0:3], a[48:51], v[148:151]
  s_waitcnt lgkmcnt(2)
  v_sub_f32 v163, v79, v163
  v_mfma_f32_16x16x32_bf16 v[148:151], a[12:15], a[52:55], v[148:151]
  v_fmac_f32 v80, 0.5, v164
  v_sub_f32 v164, v80, v164
  v_mfma_f32_16x16x32_bf16 v[148:151], a[24:27], a[44:47], v[148:151]
  v_fmac_f32 v81, 0.5, v165
  v_sub_f32 v165, v81, v165
  v_mfma_f32_16x16x32_bf16 v[152:155], a[28:31], a[44:47], v[152:155]
  v_fmac_f32 v82, 0.5, v166
  v_sub_f32 v166, v82, v166
  v_mfma_f32_16x16x32_bf16 v[152:155], a[16:19], a[52:55], v[152:155]
  ds_read_b128 v[16:19], v0 offset:22144
  v_fmac_f32 v83, 0.5, v167
  v_mfma_f32_16x16x32_bf16 v[152:155], a[4:7], a[48:51], v[152:155]
  ds_read_b128 v[20:23], v0 offset:22656
  v_sub_f32 v167, v83, v167
  v_mfma_f32_16x16x32_bf16 v[156:159], a[8:11], a[48:51], v[156:159]
  ds_read_b128 v[24:27], v0 offset:23168
  v_fmac_f32 v84, 0.5, v168
  v_mfma_f32_16x16x32_bf16 v[156:159], a[20:23], a[52:55], v[156:159]
  ds_read_b128 a[36:39], v0 offset:23680
  v_sub_f32 v168, v84, v168
  v_mfma_f32_16x16x32_bf16 v[156:159], a[32:35], a[44:47], v[156:159]
  v_fmac_f32 v85, 0.5, v169
  v_sub_f32 v169, v85, v169
  v_mfma_f32_16x16x32_bf16 v[160:163], a[0:3], a[44:47], v[160:163]
  s_waitcnt lgkmcnt(4)
  v_fmac_f32 v86, 0.5, v170
  v_mfma_f32_16x16x32_bf16 v[160:163], a[12:15], a[56:59], v[160:163]
  v_sub_f32 v170, v86, v170
  v_fmac_f32 v87, 0.5, v171
  v_mfma_f32_16x16x32_bf16 v[160:163], a[24:27], v[12:15], v[160:163]
  v_sub_f32 v171, v87, v171
  v_fmac_f32 v88, 0.5, v172
  v_mfma_f32_16x16x32_bf16 v[164:167], a[28:31], v[12:15], v[164:167]
  v_sub_f32 v172, v88, v172
  v_fmac_f32 v89, 0.5, v173
  v_mfma_f32_16x16x32_bf16 v[164:167], a[16:19], a[56:59], v[164:167]
  v_sub_f32 v173, v89, v173
  v_fmac_f32 v90, 0.5, v174
  v_mfma_f32_16x16x32_bf16 v[164:167], a[4:7], a[44:47], v[164:167]
  v_sub_f32 v174, v90, v174
  v_fmac_f32 v91, 0.5, v175
  v_mfma_f32_16x16x32_bf16 v[168:171], a[8:11], a[44:47], v[168:171]
  s_barrier
  v_sub_f32 v175, v91, v175
  v_mfma_f32_16x16x32_bf16 v[168:171], a[20:23], a[56:59], v[168:171]
  ds_read_b128 a[40:43], v0 offset:24768
  v_fmac_f32 v100, 0.5, v184
  v_mfma_f32_16x16x32_bf16 v[168:171], a[32:35], v[12:15], v[168:171]
  ds_read_b128 a[48:51], v0 offset:25280
  v_sub_f32 v184, v100, v184
  v_mfma_f32_16x16x32_bf16 v[172:175], a[0:3], v[12:15], v[172:175]
  s_waitcnt lgkmcnt(2)
  v_fmac_f32 v101, 0.5, v185
  v_sub_f32 v185, v101, v185
  v_fmac_f32 v102, 0.5, v186
  v_sub_f32 v186, v102, v186
  v_fmac_f32 v103, 0.5, v187
  v_sub_f32 v187, v103, v187
  v_mfma_f32_16x16x32_bf16 v[172:175], a[12:15], v[16:19], v[172:175]
  ds_read_b128 a[52:55], v0 offset:25792
  v_fmac_f32 v104, 0.5, v188
  v_mfma_f32_16x16x32_bf16 v[172:175], a[24:27], v[20:23], v[172:175]
  ds_read_b128 a[44:47], v0 offset:26304
  v_sub_f32 v188, v104, v188
  v_mfma_f32_16x16x32_bf16 v[184:187], a[0:3], v[20:23], v[184:187]
  ds_read_b64_tr_b16 a[0:1], v6 offset:36864
  v_fmac_f32 v105, 0.5, v189
  v_sub_f32 v189, v105, v189
  v_fmac_f32 v106, 0.5, v190
  v_sub_f32 v190, v106, v190
  v_fmac_f32 v107, 0.5, v191
  v_sub_f32 v191, v107, v191
  v_mfma_f32_16x16x32_bf16 v[184:187], a[12:15], v[24:27], v[184:187]
  ds_read_b64_tr_b16 a[2:3], v6 offset:38400
  v_fmac_f32 v92, 0.5, v176
  v_mfma_f32_16x16x32_bf16 v[184:187], a[24:27], a[36:39], v[184:187]
  ds_read_b64_tr_b16 a[12:13], v6 offset:39936
  v_sub_f32 v176, v92, v176
  v_mfma_f32_16x16x32_bf16 v[188:191], a[28:31], a[36:39], v[188:191]
  ds_read_b64_tr_b16 a[14:15], v6 offset:41472
  v_fmac_f32 v93, 0.5, v177
  v_sub_f32 v177, v93, v177
  v_fmac_f32 v94, 0.5, v178
  v_sub_f32 v178, v94, v178
  v_fmac_f32 v95, 0.5, v179
  v_sub_f32 v179, v95, v179
  v_mfma_f32_16x16x32_bf16 v[188:191], a[16:19], v[24:27], v[188:191]
  ds_read_b64_tr_b16 a[24:25], v6 offset:43008
  v_fmac_f32 v96, 0.5, v180
  v_mfma_f32_16x16x32_bf16 v[188:191], a[4:7], v[20:23], v[188:191]
  ds_read_b64_tr_b16 a[26:27], v6 offset:44544
  v_sub_f32 v180, v96, v180
  v_mfma_f32_16x16x32_bf16 v[176:179], a[28:31], v[20:23], v[176:179]
  ds_read_b64_tr_b16 a[28:29], v6 offset:43016
  v_fmac_f32 v97, 0.5, v181
  v_sub_f32 v181, v97, v181
  v_fmac_f32 v98, 0.5, v182
  v_sub_f32 v182, v98, v182
  v_fmac_f32 v99, 0.5, v183
  v_sub_f32 v183, v99, v183
  v_mfma_f32_16x16x32_bf16 v[176:179], a[16:19], v[16:19], v[176:179]
  ds_read_b64_tr_b16 a[30:31], v6 offset:44552
  ds_read_b128 a[56:59], v0 offset:26816
  v_mfma_f32_16x16x32_bf16 v[176:179], a[4:7], v[12:15], v[176:179]
  ds_read_b64_tr_b16 a[16:17], v6 offset:39944
  v_fmac_f32 v108, 0.5, v192
  v_mfma_f32_16x16x32_bf16 v[180:183], a[8:11], v[12:15], v[180:183]
  ds_read_b64_tr_b16 a[18:19], v6 offset:41480
  v_sub_f32 v192, v108, v192
  v_fmac_f32 v109, 0.5, v193
  v_sub_f32 v193, v109, v193
  v_fmac_f32 v110, 0.5, v194
  v_sub_f32 v194, v110, v194
  v_fmac_f32 v111, 0.5, v195
  v_sub_f32 v195, v111, v195
  v_mfma_f32_16x16x32_bf16 v[180:183], a[20:23], v[16:19], v[180:183]
  ds_read_b64_tr_b16 a[4:5], v6 offset:36872
  v_cvt_pk_bf16_f32 v28, v28, v29
  v_mfma_f32_16x16x32_bf16 v[180:183], a[32:35], v[20:23], v[180:183]
  ds_read_b64_tr_b16 a[6:7], v6 offset:38408
  v_cvt_pk_bf16_f32 v29, v30, v31
  v_mfma_f32_16x16x32_bf16 v[192:195], a[8:11], v[20:23], v[192:195]
  ds_read_b64_tr_b16 a[8:9], v6 offset:36880
  v_cvt_pk_bf16_f32 v32, v32, v33
  v_mfma_f32_16x16x32_bf16 v[192:195], a[20:23], v[24:27], v[192:195]
  ds_read_b64_tr_b16 a[10:11], v6 offset:38416
  v_cvt_pk_bf16_f32 v33, v34, v35
  v_mfma_f32_16x16x32_bf16 v[192:195], a[32:35], a[36:39], v[192:195]
  s_waitcnt lgkmcnt(6)
  ds_read_b64_tr_b16 a[20:21], v6 offset:39952
  v_mfma_f32_16x16x32_bf16 v[112:115], a[0:3], a[40:43], v[112:115]
  ds_read_b64_tr_b16 a[22:23], v6 offset:41488
  v_cvt_pk_bf16_f32 v36, v36, v37
  v_mfma_f32_16x16x32_bf16 v[112:115], a[12:15], a[48:51], v[112:115]
  ds_read_b64_tr_b16 a[32:33], v6 offset:43024
  v_cvt_pk_bf16_f32 v37, v38, v39
  v_mfma_f32_16x16x32_bf16 v[112:115], a[24:27], a[52:55], v[112:115]
  ds_read_b64_tr_b16 a[34:35], v6 offset:44560
  v_cvt_pk_bf16_f32 v40, v40, v41
L_pg4:
  s_cmp_lg_u32 s32, 0
  s_cbranch_scc1 L_pr4
  v_mfma_f32_16x16x32_bf16 v[124:127], a[0:3], a[52:55], v[124:127]
  ds_read_b128 v[12:15], v0 offset:27328
  ds_read_b128 v[16:19], v0 offset:27840
  v_mfma_f32_16x16x32_bf16 v[124:127], a[12:15], a[44:47], v[124:127]
  ds_read_b128 v[20:23], v0 offset:28352
  ds_read_b128 v[24:27], v0 offset:28864
  v_mfma_f32_16x16x32_bf16 v[124:127], a[24:27], a[56:59], v[124:127]
  s_waitcnt lgkmcnt(10)
  ds_read_b128 a[36:39], v0 offset:29376
  v_mfma_f32_16x16x32_bf16 v[128:131], a[28:31], a[56:59], v[128:131]
  v_cvt_pk_bf16_f32 v41, v42, v43
  v_cvt_pk_bf16_f32 v44, v44, v45
  v_mfma_f32_16x16x32_bf16 v[128:131], a[16:19], a[44:47], v[128:131]
  v_cvt_pk_bf16_f32 v45, v46, v47
  v_cvt_pk_bf16_f32 v48, v48, v49
  v_mfma_f32_16x16x32_bf16 v[128:131], a[4:7], a[52:55], v[128:131]
  v_cvt_pk_bf16_f32 v49, v50, v51
  v_cvt_pk_bf16_f32 v52, v52, v53
  v_mfma_f32_16x16x32_bf16 v[116:119], a[28:31], a[52:55], v[116:119]
  s_barrier
  v_cvt_pk_bf16_f32 v53, v54, v55
  v_mfma_f32_16x16x32_bf16 v[116:119], a[16:19], a[48:51], v[116:119]
  v_cvt_pk_bf16_f32 v56, v56, v57
  v_cvt_pk_bf16_f32 v57, v58, v59
  v_mfma_f32_16x16x32_bf16 v[116:119], a[4:7], a[40:43], v[116:119]
  s_waitcnt lgkmcnt(5)
  v_cvt_pk_bf16_f32 v60, v60, v61
  v_mfma_f32_16x16x32_bf16 v[120:123], a[8:11], a[40:43], v[120:123]
  v_cvt_pk_bf16_f32 v61, v62, v63
  v_mfma_f32_16x16x32_bf16 v[120:123], a[20:23], a[48:51], v[120:123]
  v_mfma_f32_16x16x32_bf16 v[120:123], a[32:35], a[52:55], v[120:123]
  v_mfma_f32_16x16x32_bf16 v[132:135], a[8:11], a[52:55], v[132:135]
  v_mfma_f32_16x16x32_bf16 v[132:135], a[20:23], a[44:47], v[132:135]
  v_mfma_f32_16x16x32_bf16 v[132:135], a[32:35], a[56:59], v[132:135]
  v_mfma_f32_16x16x32_bf16 v[136:139], a[0:3], a[56:59], v[136:139]
  s_waitcnt lgkmcnt(3)
  v_mfma_f32_16x16x32_bf16 v[136:139], a[12:15], v[12:15], v[136:139]
  v_mfma_f32_16x16x32_bf16 v[136:139], a[24:27], v[16:19], v[136:139]
  v_mfma_f32_16x16x32_bf16 v[140:143], a[28:31], v[16:19], v[140:143]
  v_mfma_f32_16x16x32_bf16 v[140:143], a[16:19], v[12:15], v[140:143]
  ds_write_b64 v8, v[28:29] offset:6272
  v_mfma_f32_16x16x32_bf16 v[140:143], a[4:7], a[56:59], v[140:143]
  ds_write_b64 v8, v[32:33] offset:6280
  v_mfma_f32_16x16x32_bf16 v[144:147], a[8:11], a[56:59], v[144:147]
  ds_write_b64 v8, v[36:37] offset:6288
  v_mfma_f32_16x16x32_bf16 v[144:147], a[20:23], v[12:15], v[144:147]
  ds_write_b64 v8, v[40:41] offset:12544
  v_mfma_f32_16x16x32_bf16 v[144:147], a[32:35], v[16:19], v[144:147]
  ds_write_b64 v8, v[44:45] offset:12552
  v_mfma_f32_16x16x32_bf16 v[148:151], a[0:3], v[16:19], v[148:151]
  s_waitcnt lgkmcnt(6)
  ds_write_b64 v8, v[48:49] offset:12560
  v_mfma_f32_16x16x32_bf16 v[148:151], a[12:15], v[20:23], v[148:151]
  ds_write_b64 v8, v[52:53] offset:18816
  v_mfma_f32_16x16x32_bf16 v[148:151], a[24:27], v[24:27], v[148:151]
  ds_write_b64 v8, v[56:57] offset:18824
  v_mfma_f32_16x16x32_bf16 v[152:155], a[28:31], v[24:27], v[152:155]
  ds_write_b64 v8, v[60:61] offset:18832
  v_mfma_f32_16x16x32_bf16 v[152:155], a[16:19], v[20:23], v[152:155]
  ds_read_b128 a[40:43], v0 offset:29888
  v_mfma_f32_16x16x32_bf16 v[152:155], a[4:7], v[16:19], v[152:155]
  ds_read_b128 a[48:51], v0 offset:30400
  v_mfma_f32_16x16x32_bf16 v[156:159], a[8:11], v[16:19], v[156:159]
  ds_read_b128 a[52:55], v0 offset:30912
  v_mfma_f32_16x16x32_bf16 v[156:159], a[20:23], v[20:23], v[156:159]
  ds_read_b128 a[44:47], v0 offset:31424
  v_mfma_f32_16x16x32_bf16 v[156:159], a[32:35], v[24:27], v[156:159]
  ds_read_b128 a[56:59], v0 offset:31936
  v_mfma_f32_16x16x32_bf16 v[160:163], a[0:3], v[24:27], v[160:163]
  s_waitcnt lgkmcnt(4)
  v_mfma_f32_16x16x32_bf16 v[160:163], a[12:15], a[36:39], v[160:163]
  v_mfma_f32_16x16x32_bf16 v[160:163], a[24:27], a[40:43], v[160:163]
  v_mfma_f32_16x16x32_bf16 v[164:167], a[28:31], a[40:43], v[164:167]
  v_mfma_f32_16x16x32_bf16 v[164:167], a[16:19], a[36:39], v[164:167]
  v_mfma_f32_16x16x32_bf16 v[164:167], a[4:7], v[24:27], v[164:167]
  v_mfma_f32_16x16x32_bf16 v[168:171], a[8:11], v[24:27], v[168:171]
  s_barrier
  v_mfma_f32_16x16x32_bf16 v[168:171], a[20:23], a[36:39], v[168:171]
  ds_read_b128 v[12:15], v0 offset:0
  v_mfma_f32_16x16x32_bf16 v[168:171], a[32:35], a[40:43], v[168:171]
  ds_read_b128 v[16:19], v0 offset:512
  v_mfma_f32_16x16x32_bf16 v[172:175], a[0:3], a[40:43], v[172:175]
  s_waitcnt lgkmcnt(2)
  v_mfma_f32_16x16x32_bf16 v[172:175], a[12:15], a[48:51], v[172:175]
  ds_read_b128 v[20:23], v0 offset:1024
  v_mfma_f32_16x16x32_bf16 v[172:175], a[24:27], a[52:55], v[172:175]
  ds_read_b128 v[24:27], v0 offset:1536
  v_mfma_f32_16x16x32_bf16 v[184:187], a[0:3], a[52:55], v[184:187]
  ds_read_b64_tr_b16 a[0:1], v6 offset:0
  v_mfma_f32_16x16x32_bf16 v[184:187], a[12:15], a[44:47], v[184:187]
  ds_read_b64_tr_b16 a[2:3], v6 offset:1536
  v_mfma_f32_16x16x32_bf16 v[184:187], a[24:27], a[56:59], v[184:187]
  ds_read_b64_tr_b16 a[12:13], v6 offset:3072
  v_mfma_f32_16x16x32_bf16 v[188:191], a[28:31], a[56:59], v[188:191]
  ds_read_b64_tr_b16 a[14:15], v6 offset:4608
  v_mfma_f32_16x16x32_bf16 v[188:191], a[16:19], a[44:47], v[188:191]
  ds_read_b64_tr_b16 a[24:25], v6 offset:6144
  v_mfma_f32_16x16x32_bf16 v[188:191], a[4:7], a[52:55], v[188:191]
  ds_read_b64_tr_b16 a[26:27], v6 offset:7680
  v_mfma_f32_16x16x32_bf16 v[176:179], a[28:31], a[52:55], v[176:179]
  ds_read_b64_tr_b16 a[28:29], v6 offset:6152
  v_mfma_f32_16x16x32_bf16 v[176:179], a[16:19], a[48:51], v[176:179]
  ds_read_b64_tr_b16 a[30:31], v6 offset:7688
  ds_read_b128 a[36:39], v0 offset:2048
  v_mfma_f32_16x16x32_bf16 v[176:179], a[4:7], a[40:43], v[176:179]
  ds_read_b64_tr_b16 a[16:17], v6 offset:3080
  v_mfma_f32_16x16x32_bf16 v[180:183], a[8:11], a[40:43], v[180:183]
  ds_read_b64_tr_b16 a[18:19], v6 offset:4616
  v_mfma_f32_16x16x32_bf16 v[180:183], a[20:23], a[48:51], v[180:183]
  ds_read_b64_tr_b16 a[4:5], v6 offset:8
  v_mfma_f32_16x16x32_bf16 v[180:183], a[32:35], a[52:55], v[180:183]
  ds_read_b64_tr_b16 a[6:7], v6 offset:1544
  v_mfma_f32_16x16x32_bf16 v[192:195], a[8:11], a[52:55], v[192:195]
  ds_read_b64_tr_b16 a[8:9], v6 offset:16
  v_mfma_f32_16x16x32_bf16 v[192:195], a[20:23], a[44:47], v[192:195]
  ds_read_b64_tr_b16 a[10:11], v6 offset:1552
  v_mfma_f32_16x16x32_bf16 v[192:195], a[32:35], a[56:59], v[192:195]
  s_waitcnt lgkmcnt(6)
  ds_read_b64_tr_b16 a[20:21], v6 offset:3088
  v_mfma_f32_16x16x32_bf16 v[112:115], a[0:3], v[12:15], v[112:115]
  ds_read_b64_tr_b16 a[22:23], v6 offset:4624
  v_mfma_f32_16x16x32_bf16 v[112:115], a[12:15], v[16:19], v[112:115]
  ds_read_b64_tr_b16 a[32:33], v6 offset:6160
  v_mfma_f32_16x16x32_bf16 v[112:115], a[24:27], v[20:23], v[112:115]
  ds_read_b64_tr_b16 a[34:35], v6 offset:7696
  v_mfma_f32_16x16x32_bf16 v[124:127], a[0:3], v[20:23], v[124:127]
  v_mfma_f32_16x16x32_bf16 v[124:127], a[12:15], v[24:27], v[124:127]
  ds_read_b128 a[40:43], v0 offset:2560
  v_mfma_f32_16x16x32_bf16 v[124:127], a[24:27], a[36:39], v[124:127]
  s_waitcnt lgkmcnt(7)
  v_mfma_f32_16x16x32_bf16 v[128:131], a[28:31], a[36:39], v[128:131]
  ds_read_b128 a[48:51], v0 offset:3072
  v_mfma_f32_16x16x32_bf16 v[128:131], a[16:19], v[24:27], v[128:131]
  v_mfma_f32_16x16x32_bf16 v[128:131], a[4:7], v[20:23], v[128:131]
  v_mfma_f32_16x16x32_bf16 v[116:119], a[28:31], v[20:23], v[116:119]
  v_cvt_pk_bf16_f32 v76, v76, v77
  v_mfma_f32_16x16x32_bf16 v[116:119], a[16:19], v[16:19], v[116:119]
  v_cvt_pk_bf16_f32 v77, v78, v79
  v_mfma_f32_16x16x32_bf16 v[116:119], a[4:7], v[12:15], v[116:119]
  s_waitcnt lgkmcnt(2)
  v_mfma_f32_16x16x32_bf16 v[120:123], a[8:11], v[12:15], v[120:123]
  v_cvt_pk_bf16_f32 v80, v80, v81
  v_mfma_f32_16x16x32_bf16 v[120:123], a[20:23], v[16:19], v[120:123]
  ds_read_b128 a[52:55], v0 offset:3584
  v_mfma_f32_16x16x32_bf16 v[120:123], a[32:35], v[20:23], v[120:123]
  ds_read_b128 a[44:47], v0 offset:4096
  v_mfma_f32_16x16x32_bf16 v[132:135], a[8:11], v[20:23], v[132:135]
  v_cvt_pk_bf16_f32 v81, v82, v83
  v_mfma_f32_16x16x32_bf16 v[132:135], a[20:23], v[24:27], v[132:135]
  v_cvt_pk_bf16_f32 v84, v84, v85
  v_mfma_f32_16x16x32_bf16 v[132:135], a[32:35], a[36:39], v[132:135]
  v_cvt_pk_bf16_f32 v85, v86, v87
  v_mfma_f32_16x16x32_bf16 v[136:139], a[0:3], a[36:39], v[136:139]
  s_waitcnt lgkmcnt(2)
  v_mfma_f32_16x16x32_bf16 v[136:139], a[12:15], a[40:43], v[136:139]
  v_cvt_pk_bf16_f32 v88, v88, v89
  v_mfma_f32_16x16x32_bf16 v[136:139], a[24:27], a[48:51], v[136:139]
  v_cvt_pk_bf16_f32 v89, v90, v91
  v_mfma_f32_16x16x32_bf16 v[140:143], a[28:31], a[48:51], v[140:143]
  v_cvt_pk_bf16_f32 v92, v92, v93
  v_mfma_f32_16x16x32_bf16 v[140:143], a[16:19], a[40:43], v[140:143]
  ds_read_b128 a[56:59], v0 offset:4608
  v_mfma_f32_16x16x32_bf16 v[140:143], a[4:7], a[36:39], v[140:143]
  ds_read_b128 v[12:15], v0 offset:5120
  v_mfma_f32_16x16x32_bf16 v[144:147], a[8:11], a[36:39], v[144:147]
  v_cvt_pk_bf16_f32 v93, v94, v95
  v_mfma_f32_16x16x32_bf16 v[144:147], a[20:23], a[40:43], v[144:147]
  v_cvt_pk_bf16_f32 v96, v96, v97
  v_mfma_f32_16x16x32_bf16 v[144:147], a[32:35], a[48:51], v[144:147]
  v_cvt_pk_bf16_f32 v97, v98, v99
  v_mfma_f32_16x16x32_bf16 v[148:151], a[0:3], a[48:51], v[148:151]
  s_waitcnt lgkmcnt(2)
  v_mfma_f32_16x16x32_bf16 v[148:151], a[12:15], a[52:55], v[148:151]
  v_cvt_pk_bf16_f32 v64, v64, v65
  v_mfma_f32_16x16x32_bf16 v[148:151], a[24:27], a[44:47], v[148:151]
  v_cvt_pk_bf16_f32 v65, v66, v67
  v_mfma_f32_16x16x32_bf16 v[152:155], a[28:31], a[44:47], v[152:155]
  v_cvt_pk_bf16_f32 v68, v68, v69
  v_mfma_f32_16x16x32_bf16 v[152:155], a[16:19], a[52:55], v[152:155]
  ds_read_b128 v[16:19], v0 offset:5632
  v_mfma_f32_16x16x32_bf16 v[152:155], a[4:7], a[48:51], v[152:155]
  ds_read_b128 v[20:23], v0 offset:6144
  v_mfma_f32_16x16x32_bf16 v[156:159], a[8:11], a[48:51], v[156:159]
  ds_read_b128 v[24:27], v0 offset:6656
  v_mfma_f32_16x16x32_bf16 v[156:159], a[20:23], a[52:55], v[156:159]
  ds_read_b128 a[36:39], v0 offset:7168
  v_mfma_f32_16x16x32_bf16 v[156:159], a[32:35], a[44:47], v[156:159]
  v_cvt_pk_bf16_f32 v69, v70, v71
  v_mfma_f32_16x16x32_bf16 v[160:163], a[0:3], a[44:47], v[160:163]
  s_waitcnt lgkmcnt(4)
  v_mfma_f32_16x16x32_bf16 v[160:163], a[12:15], a[56:59], v[160:163]
  v_cvt_pk_bf16_f32 v72, v72, v73
  v_mfma_f32_16x16x32_bf16 v[160:163], a[24:27], v[12:15], v[160:163]
  v_cvt_pk_bf16_f32 v73, v74, v75
  v_mfma_f32_16x16x32_bf16 v[164:167], a[28:31], v[12:15], v[164:167]
  v_cvt_pk_bf16_f32 v100, v100, v101
  v_mfma_f32_16x16x32_bf16 v[164:167], a[16:19], a[56:59], v[164:167]
  v_cvt_pk_bf16_f32 v101, v102, v103
  v_mfma_f32_16x16x32_bf16 v[164:167], a[4:7], a[44:47], v[164:167]
  v_cvt_pk_bf16_f32 v104, v104, v105
  v_mfma_f32_16x16x32_bf16 v[168:171], a[8:11], a[44:47], v[168:171]
  s_barrier
  v_mfma_f32_16x16x32_bf16 v[168:171], a[20:23], a[56:59], v[168:171]
  ds_read_b128 a[40:43], v0 offset:8256
  v_mfma_f32_16x16x32_bf16 v[168:171], a[32:35], v[12:15], v[168:171]
  ds_read_b128 a[48:51], v0 offset:8768
  v_mfma_f32_16x16x32_bf16 v[172:175], a[0:3], v[12:15], v[172:175]
  s_waitcnt lgkmcnt(2)
  v_mfma_f32_16x16x32_bf16 v[172:175], a[12:15], v[16:19], v[172:175]
  ds_read_b128 a[52:55], v0 offset:9280
  v_mfma_f32_16x16x32_bf16 v[172:175], a[24:27], v[20:23], v[172:175]
  ds_read_b128 a[44:47], v0 offset:9792
  v_mfma_f32_16x16x32_bf16 v[184:187], a[0:3], v[20:23], v[184:187]
  ds_read_b64_tr_b16 a[0:1], v7 offset:0
  v_mfma_f32_16x16x32_bf16 v[184:187], a[12:15], v[24:27], v[184:187]
  ds_read_b64_tr_b16 a[2:3], v7 offset:1536
  v_mfma_f32_16x16x32_bf16 v[184:187], a[24:27], a[36:39], v[184:187]
  ds_read_b64_tr_b16 a[12:13], v7 offset:3072
  v_mfma_f32_16x16x32_bf16 v[188:191], a[28:31], a[36:39], v[188:191]
  ds_read_b64_tr_b16 a[14:15], v7 offset:4608
  v_mfma_f32_16x16x32_bf16 v[188:191], a[16:19], v[24:27], v[188:191]
  ds_read_b64_tr_b16 a[24:25], v7 offset:6144
  v_mfma_f32_16x16x32_bf16 v[188:191], a[4:7], v[20:23], v[188:191]
  ds_read_b64_tr_b16 a[26:27], v7 offset:7680
  v_mfma_f32_16x16x32_bf16 v[176:179], a[28:31], v[20:23], v[176:179]
  ds_read_b64_tr_b16 a[28:29], v7 offset:6152
  v_mfma_f32_16x16x32_bf16 v[176:179], a[16:19], v[16:19], v[176:179]
  ds_read_b64_tr_b16 a[30:31], v7 offset:7688
  ds_read_b128 a[56:59], v0 offset:10304
  v_mfma_f32_16x16x32_bf16 v[176:179], a[4:7], v[12:15], v[176:179]
  ds_read_b64_tr_b16 a[16:17], v7 offset:3080
  v_mfma_f32_16x16x32_bf16 v[180:183], a[8:11], v[12:15], v[180:183]
  ds_read_b64_tr_b16 a[18:19], v7 offset:4616
  v_mfma_f32_16x16x32_bf16 v[180:183], a[20:23], v[16:19], v[180:183]
  ds_read_b64_tr_b16 a[4:5], v7 offset:8
  v_mfma_f32_16x16x32_bf16 v[180:183], a[32:35], v[20:23], v[180:183]
  ds_read_b64_tr_b16 a[6:7], v7 offset:1544
  v_mfma_f32_16x16x32_bf16 v[192:195], a[8:11], v[20:23], v[192:195]
  ds_read_b64_tr_b16 a[8:9], v7 offset:16
  v_mfma_f32_16x16x32_bf16 v[192:195], a[20:23], v[24:27], v[192:195]
  ds_read_b64_tr_b16 a[10:11], v7 offset:1552
  v_mfma_f32_16x16x32_bf16 v[192:195], a[32:35], a[36:39], v[192:195]
  s_waitcnt lgkmcnt(6)
  ds_read_b64_tr_b16 a[20:21], v7 offset:3088
  v_mfma_f32_16x16x32_bf16 v[112:115], a[0:3], a[40:43], v[112:115]
  ds_read_b64_tr_b16 a[22:23], v7 offset:4624
  v_mfma_f32_16x16x32_bf16 v[112:115], a[12:15], a[48:51], v[112:115]
  ds_read_b64_tr_b16 a[32:33], v7 offset:6160
  v_mfma_f32_16x16x32_bf16 v[112:115], a[24:27], a[52:55], v[112:115]
  ds_read_b64_tr_b16 a[34:35], v7 offset:7696
  v_mfma_f32_16x16x32_bf16 v[124:127], a[0:3], a[52:55], v[124:127]
  ds_read_b128 v[12:15], v0 offset:10816
  ds_read_b128 v[16:19], v0 offset:11328
  v_mfma_f32_16x16x32_bf16 v[124:127], a[12:15], a[44:47], v[124:127]
  ds_read_b128 v[20:23], v0 offset:11840
  ds_read_b128 v[24:27], v0 offset:12352
  v_mfma_f32_16x16x32_bf16 v[124:127], a[24:27], a[56:59], v[124:127]
  s_waitcnt lgkmcnt(10)
  ds_read_b128 a[36:39], v0 offset:12864
  v_mfma_f32_16x16x32_bf16 v[128:131], a[28:31], a[56:59], v[128:131]
  v_cvt_pk_bf16_f32 v105, v106, v107
  v_mfma_f32_16x16x32_bf16 v[128:131], a[16:19], a[44:47], v[128:131]
  v_cvt_pk_bf16_f32 v108, v108, v109
  v_mfma_f32_16x16x32_bf16 v[128:131], a[4:7], a[52:55], v[128:131]
  v_cvt_pk_bf16_f32 v109, v110, v111
  v_mfma_f32_16x16x32_bf16 v[116:119], a[28:31], a[52:55], v[116:119]
  s_barrier
  v_mfma_f32_16x16x32_bf16 v[116:119], a[16:19], a[48:51], v[116:119]
  v_mfma_f32_16x16x32_bf16 v[116:119], a[4:7], a[40:43], v[116:119]
  s_waitcnt lgkmcnt(5)
  v_mfma_f32_16x16x32_bf16 v[120:123], a[8:11], a[40:43], v[120:123]
  v_mfma_f32_16x16x32_bf16 v[120:123], a[20:23], a[48:51], v[120:123]
  v_mfma_f32_16x16x32_bf16 v[120:123], a[32:35], a[52:55], v[120:123]
  v_mfma_f32_16x16x32_bf16 v[132:135], a[8:11], a[52:55], v[132:135]
  v_mfma_f32_16x16x32_bf16 v[132:135], a[20:23], a[44:47], v[132:135]
  v_mfma_f32_16x16x32_bf16 v[132:135], a[32:35], a[56:59], v[132:135]
  v_mfma_f32_16x16x32_bf16 v[136:139], a[0:3], a[56:59], v[136:139]
  s_waitcnt lgkmcnt(3)
  v_mfma_f32_16x16x32_bf16 v[136:139], a[12:15], v[12:15], v[136:139]
  v_mfma_f32_16x16x32_bf16 v[136:139], a[24:27], v[16:19], v[136:139]
  v_mfma_f32_16x16x32_bf16 v[140:143], a[28:31], v[16:19], v[140:143]
  v_mfma_f32_16x16x32_bf16 v[140:143], a[16:19], v[12:15], v[140:143]
  ds_write_b64 v8, v[76:77] offset:6272
  v_mfma_f32_16x16x32_bf16 v[140:143], a[4:7], a[56:59], v[140:143]
  ds_write_b64 v8, v[80:81] offset:6280
  v_mfma_f32_16x16x32_bf16 v[144:147], a[8:11], a[56:59], v[144:147]
  ds_write_b64 v8, v[84:85] offset:6288
  v_mfma_f32_16x16x32_bf16 v[144:147], a[20:23], v[12:15], v[144:147]
  ds_write_b64 v8, v[88:89] offset:12544
  v_mfma_f32_16x16x32_bf16 v[144:147], a[32:35], v[16:19], v[144:147]
  ds_write_b64 v8, v[92:93] offset:12552
  v_mfma_f32_16x16x32_bf16 v[148:151], a[0:3], v[16:19], v[148:151]
  s_waitcnt lgkmcnt(6)
  ds_write_b64 v8, v[96:97] offset:12560
  v_mfma_f32_16x16x32_bf16 v[148:151], a[12:15], v[20:23], v[148:151]
  ds_write_b64 v8, v[64:65] offset:18816
  v_mfma_f32_16x16x32_bf16 v[148:151], a[24:27], v[24:27], v[148:151]
  ds_write_b64 v8, v[68:69] offset:18824
  v_mfma_f32_16x16x32_bf16 v[152:155], a[28:31], v[24:27], v[152:155]
  ds_write_b64 v8, v[72:73] offset:18832
  v_mfma_f32_16x16x32_bf16 v[152:155], a[16:19], v[20:23], v[152:155]
  ds_read_b128 a[40:43], v0 offset:13376
  v_mfma_f32_16x16x32_bf16 v[152:155], a[4:7], v[16:19], v[152:155]
  ds_read_b128 a[48:51], v0 offset:13888
  v_mfma_f32_16x16x32_bf16 v[156:159], a[8:11], v[16:19], v[156:159]
  ds_read_b128 a[52:55], v0 offset:14400
  v_mfma_f32_16x16x32_bf16 v[156:159], a[20:23], v[20:23], v[156:159]
  ds_read_b128 a[44:47], v0 offset:14912
  v_mfma_f32_16x16x32_bf16 v[156:159], a[32:35], v[24:27], v[156:159]
  ds_read_b128 a[56:59], v0 offset:15424
  v_mfma_f32_16x16x32_bf16 v[160:163], a[0:3], v[24:27], v[160:163]
  s_waitcnt lgkmcnt(4)
  v_mfma_f32_16x16x32_bf16 v[160:163], a[12:15], a[36:39], v[160:163]
  v_mfma_f32_16x16x32_bf16 v[160:163], a[24:27], a[40:43], v[160:163]
  v_mfma_f32_16x16x32_bf16 v[164:167], a[28:31], a[40:43], v[164:167]
  v_mfma_f32_16x16x32_bf16 v[164:167], a[16:19], a[36:39], v[164:167]
  v_mfma_f32_16x16x32_bf16 v[164:167], a[4:7], v[24:27], v[164:167]
  v_mfma_f32_16x16x32_bf16 v[168:171], a[8:11], v[24:27], v[168:171]
  s_barrier
  v_mfma_f32_16x16x32_bf16 v[168:171], a[20:23], a[36:39], v[168:171]
  ds_read_b128 v[12:15], v0 offset:16512
  v_mfma_f32_16x16x32_bf16 v[168:171], a[32:35], a[40:43], v[168:171]
  ds_read_b128 v[16:19], v0 offset:17024
  v_mfma_f32_16x16x32_bf16 v[172:175], a[0:3], a[40:43], v[172:175]
  s_waitcnt lgkmcnt(2)
  v_mfma_f32_16x16x32_bf16 v[172:175], a[12:15], a[48:51], v[172:175]
  ds_read_b128 v[20:23], v0 offset:17536
  v_mfma_f32_16x16x32_bf16 v[172:175], a[24:27], a[52:55], v[172:175]
  ds_read_b128 v[24:27], v0 offset:18048
  v_mfma_f32_16x16x32_bf16 v[184:187], a[0:3], a[52:55], v[184:187]
  ds_read_b64_tr_b16 a[0:1], v6 offset:36864
  v_mfma_f32_16x16x32_bf16 v[184:187], a[12:15], a[44:47], v[184:187]
  ds_read_b64_tr_b16 a[2:3], v6 offset:38400
  v_mfma_f32_16x16x32_bf16 v[184:187], a[24:27], a[56:59], v[184:187]
  ds_read_b64_tr_b16 a[12:13], v6 offset:39936
  v_mfma_f32_16x16x32_bf16 v[188:191], a[28:31], a[56:59], v[188:191]
  ds_read_b64_tr_b16 a[14:15], v6 offset:41472
  v_mfma_f32_16x16x32_bf16 v[188:191], a[16:19], a[44:47], v[188:191]
  ds_read_b64_tr_b16 a[24:25], v6 offset:43008
  v_mfma_f32_16x16x32_bf16 v[188:191], a[4:7], a[52:55], v[188:191]
  ds_read_b64_tr_b16 a[26:27], v6 offset:44544
  v_mfma_f32_16x16x32_bf16 v[176:179], a[28:31], a[52:55], v[176:179]
  ds_read_b64_tr_b16 a[28:29], v6 offset:43016
  v_mfma_f32_16x16x32_bf16 v[176:179], a[16:19], a[48:51], v[176:179]
  ds_read_b64_tr_b16 a[30:31], v6 offset:44552
  ds_read_b128 a[36:39], v0 offset:18560
  v_mfma_f32_16x16x32_bf16 v[176:179], a[4:7], a[40:43], v[176:179]
  ds_read_b64_tr_b16 a[16:17], v6 offset:39944
  v_mfma_f32_16x16x32_bf16 v[180:183], a[8:11], a[40:43], v[180:183]
  ds_read_b64_tr_b16 a[18:19], v6 offset:41480
  v_mfma_f32_16x16x32_bf16 v[180:183], a[20:23], a[48:51], v[180:183]
  ds_read_b64_tr_b16 a[4:5], v6 offset:36872
  v_mfma_f32_16x16x32_bf16 v[180:183], a[32:35], a[52:55], v[180:183]
  ds_read_b64_tr_b16 a[6:7], v6 offset:38408
  v_mfma_f32_16x16x32_bf16 v[192:195], a[8:11], a[52:55], v[192:195]
  ds_read_b64_tr_b16 a[8:9], v6 offset:36880
  v_mfma_f32_16x16x32_bf16 v[192:195], a[20:23], a[44:47], v[192:195]
  ds_read_b64_tr_b16 a[10:11], v6 offset:38416
  v_mfma_f32_16x16x32_bf16 v[192:195], a[32:35], a[56:59], v[192:195]
  s_waitcnt lgkmcnt(6)
  ds_read_b64_tr_b16 a[20:21], v6 offset:39952
  v_mfma_f32_16x16x32_bf16 v[112:115], a[0:3], v[12:15], v[112:115]
  ds_read_b64_tr_b16 a[22:23], v6 offset:41488
  v_mfma_f32_16x16x32_bf16 v[112:115], a[12:15], v[16:19], v[112:115]
  ds_read_b64_tr_b16 a[32:33], v6 offset:43024
  v_mfma_f32_16x16x32_bf16 v[112:115], a[24:27], v[20:23], v[112:115]
  ds_read_b64_tr_b16 a[34:35], v6 offset:44560
  v_mfma_f32_16x16x32_bf16 v[124:127], a[0:3], v[20:23], v[124:127]
  v_mfma_f32_16x16x32_bf16 v[124:127], a[12:15], v[24:27], v[124:127]
  ds_read_b128 a[40:43], v0 offset:19072
  v_mfma_f32_16x16x32_bf16 v[124:127], a[24:27], a[36:39], v[124:127]
  s_waitcnt lgkmcnt(7)
  v_mfma_f32_16x16x32_bf16 v[128:131], a[28:31], a[36:39], v[128:131]
  ds_read_b128 a[48:51], v0 offset:19584
  v_mfma_f32_16x16x32_bf16 v[128:131], a[16:19], v[24:27], v[128:131]
  v_mfma_f32_16x16x32_bf16 v[128:131], a[4:7], v[20:23], v[128:131]
  v_mfma_f32_16x16x32_bf16 v[116:119], a[28:31], v[20:23], v[116:119]
  v_mfma_f32_16x16x32_bf16 v[116:119], a[16:19], v[16:19], v[116:119]
  v_mfma_f32_16x16x32_bf16 v[116:119], a[4:7], v[12:15], v[116:119]
  s_waitcnt lgkmcnt(2)
  v_mfma_f32_16x16x32_bf16 v[120:123], a[8:11], v[12:15], v[120:123]
  v_mfma_f32_16x16x32_bf16 v[120:123], a[20:23], v[16:19], v[120:123]
  ds_read_b128 a[52:55], v0 offset:20096
  v_mfma_f32_16x16x32_bf16 v[120:123], a[32:35], v[20:23], v[120:123]
  ds_read_b128 a[44:47], v0 offset:20608
  v_mfma_f32_16x16x32_bf16 v[132:135], a[8:11], v[20:23], v[132:135]
  v_mfma_f32_16x16x32_bf16 v[132:135], a[20:23], v[24:27], v[132:135]
  v_mfma_f32_16x16x32_bf16 v[132:135], a[32:35], a[36:39], v[132:135]
  v_mfma_f32_16x16x32_bf16 v[136:139], a[0:3], a[36:39], v[136:139]
  s_waitcnt lgkmcnt(2)
  v_mfma_f32_16x16x32_bf16 v[136:139], a[12:15], a[40:43], v[136:139]
  ds_write_b64 v8, v[100:101] offset:0
  v_mfma_f32_16x16x32_bf16 v[136:139], a[24:27], a[48:51], v[136:139]
  ds_write_b64 v8, v[104:105] offset:8
  v_mfma_f32_16x16x32_bf16 v[140:143], a[28:31], a[48:51], v[140:143]
  ds_write_b64 v8, v[108:109] offset:16
  v_mfma_f32_16x16x32_bf16 v[140:143], a[16:19], a[40:43], v[140:143]
  ds_read_b128 a[56:59], v0 offset:21120
  v_mfma_f32_16x16x32_bf16 v[140:143], a[4:7], a[36:39], v[140:143]
  ds_read_b128 v[12:15], v0 offset:21632
  v_mfma_f32_16x16x32_bf16 v[144:147], a[8:11], a[36:39], v[144:147]
  v_mfma_f32_16x16x32_bf16 v[144:147], a[20:23], a[40:43], v[144:147]
  v_mfma_f32_16x16x32_bf16 v[144:147], a[32:35], a[48:51], v[144:147]
  v_mfma_f32_16x16x32_bf16 v[148:151], a[0:3], a[48:51], v[148:151]
  s_waitcnt lgkmcnt(5)
  v_mfma_f32_16x16x32_bf16 v[148:151], a[12:15], a[52:55], v[148:151]
  v_mfma_f32_16x16x32_bf16 v[148:151], a[24:27], a[44:47], v[148:151]
  v_mfma_f32_16x16x32_bf16 v[152:155], a[28:31], a[44:47], v[152:155]
  v_mfma_f32_16x16x32_bf16 v[152:155], a[16:19], a[52:55], v[152:155]
  ds_read_b128 v[16:19], v0 offset:22144
  v_mfma_f32_16x16x32_bf16 v[152:155], a[4:7], a[48:51], v[152:155]
  ds_read_b128 v[20:23], v0 offset:22656
  v_mfma_f32_16x16x32_bf16 v[156:159], a[8:11], a[48:51], v[156:159]
  ds_read_b128 v[24:27], v0 offset:23168
  v_mfma_f32_16x16x32_bf16 v[156:159], a[20:23], a[52:55], v[156:159]
  ds_read_b128 a[36:39], v0 offset:23680
  v_mfma_f32_16x16x32_bf16 v[156:159], a[32:35], a[44:47], v[156:159]
  v_mfma_f32_16x16x32_bf16 v[160:163], a[0:3], a[44:47], v[160:163]
  s_waitcnt lgkmcnt(4)
  v_mfma_f32_16x16x32_bf16 v[160:163], a[12:15], a[56:59], v[160:163]
  v_mfma_f32_16x16x32_bf16 v[160:163], a[24:27], v[12:15], v[160:163]
  v_mfma_f32_16x16x32_bf16 v[164:167], a[28:31], v[12:15], v[164:167]
  v_mfma_f32_16x16x32_bf16 v[164:167], a[16:19], a[56:59], v[164:167]
  v_mfma_f32_16x16x32_bf16 v[164:167], a[4:7], a[44:47], v[164:167]
  v_mfma_f32_16x16x32_bf16 v[168:171], a[8:11], a[44:47], v[168:171]
  s_barrier
  v_mfma_f32_16x16x32_bf16 v[168:171], a[20:23], a[56:59], v[168:171]
  ds_read_b128 a[40:43], v0 offset:24768
  v_add_u32 v8, 4294899840, v8
  v_mfma_f32_16x16x32_bf16 v[168:171], a[32:35], v[12:15], v[168:171]
  ds_read_b128 a[48:51], v0 offset:25280
  v_mfma_f32_16x16x32_bf16 v[172:175], a[0:3], v[12:15], v[172:175]
  s_waitcnt lgkmcnt(2)
  v_mfma_f32_16x16x32_bf16 v[172:175], a[12:15], v[16:19], v[172:175]
  ds_read_b128 a[52:55], v0 offset:25792
  v_mfma_f32_16x16x32_bf16 v[172:175], a[24:27], v[20:23], v[172:175]
  ds_read_b128 a[44:47], v0 offset:26304
  v_mfma_f32_16x16x32_bf16 v[184:187], a[0:3], v[20:23], v[184:187]
  ds_read_b64_tr_b16 a[0:1], v6 offset:0
  v_mfma_f32_16x16x32_bf16 v[184:187], a[12:15], v[24:27], v[184:187]
  ds_read_b64_tr_b16 a[2:3], v6 offset:1536
  v_mfma_f32_16x16x32_bf16 v[184:187], a[24:27], a[36:39], v[184:187]
  ds_read_b64_tr_b16 a[12:13], v6 offset:3072
  v_mfma_f32_16x16x32_bf16 v[188:191], a[28:31], a[36:39], v[188:191]
  ds_read_b64_tr_b16 a[14:15], v6 offset:4608
  v_mfma_f32_16x16x32_bf16 v[188:191], a[16:19], v[24:27], v[188:191]
  ds_read_b64_tr_b16 a[24:25], v6 offset:6144
  v_mfma_f32_16x16x32_bf16 v[188:191], a[4:7], v[20:23], v[188:191]
  ds_read_b64_tr_b16 a[26:27], v6 offset:7680
  v_mfma_f32_16x16x32_bf16 v[176:179], a[28:31], v[20:23], v[176:179]
  ds_read_b64_tr_b16 a[28:29], v6 offset:6152
  v_mfma_f32_16x16x32_bf16 v[176:179], a[16:19], v[16:19], v[176:179]
  ds_read_b64_tr_b16 a[30:31], v6 offset:7688
  ds_read_b128 a[56:59], v0 offset:26816
  v_mfma_f32_16x16x32_bf16 v[176:179], a[4:7], v[12:15], v[176:179]
  ds_read_b64_tr_b16 a[16:17], v6 offset:3080
  v_mfma_f32_16x16x32_bf16 v[180:183], a[8:11], v[12:15], v[180:183]
  ds_read_b64_tr_b16 a[18:19], v6 offset:4616
  v_mfma_f32_16x16x32_bf16 v[180:183], a[20:23], v[16:19], v[180:183]
  ds_read_b64_tr_b16 a[4:5], v6 offset:8
  v_mfma_f32_16x16x32_bf16 v[180:183], a[32:35], v[20:23], v[180:183]
  ds_read_b64_tr_b16 a[6:7], v6 offset:1544
  v_mfma_f32_16x16x32_bf16 v[192:195], a[8:11], v[20:23], v[192:195]
  ds_read_b64_tr_b16 a[8:9], v6 offset:16
  v_mfma_f32_16x16x32_bf16 v[192:195], a[20:23], v[24:27], v[192:195]
  ds_read_b64_tr_b16 a[10:11], v6 offset:1552
  v_mfma_f32_16x16x32_bf16 v[192:195], a[32:35], a[36:39], v[192:195]
  s_waitcnt lgkmcnt(6)
  ds_read_b64_tr_b16 a[20:21], v6 offset:3088
  v_mfma_f32_16x16x32_bf16 v[112:115], a[0:3], a[40:43], v[112:115]
  ds_read_b64_tr_b16 a[22:23], v6 offset:4624
  v_mfma_f32_16x16x32_bf16 v[112:115], a[12:15], a[48:51], v[112:115]
  ds_read_b64_tr_b16 a[32:33], v6 offset:6160
  v_mfma_f32_16x16x32_bf16 v[112:115], a[24:27], a[52:55], v[112:115]
  ds_read_b64_tr_b16 a[34:35], v6 offset:7696
  v_mfma_f32_16x16x32_bf16 v[124:127], a[0:3], a[52:55], v[124:127]
  v_mfma_f32_16x16x32_bf16 v[124:127], a[12:15], a[44:47], v[124:127]
  ds_read_b128 v[12:15], v0 offset:27328
  v_mfma_f32_16x16x32_bf16 v[124:127], a[24:27], a[56:59], v[124:127]
  s_waitcnt lgkmcnt(7)
  v_mfma_f32_16x16x32_bf16 v[128:131], a[28:31], a[56:59], v[128:131]
  ds_read_b128 v[16:19], v0 offset:27840
  v_mfma_f32_16x16x32_bf16 v[128:131], a[16:19], a[44:47], v[128:131]
  v_mfma_f32_16x16x32_bf16 v[128:131], a[4:7], a[52:55], v[128:131]
  v_mfma_f32_16x16x32_bf16 v[116:119], a[28:31], a[52:55], v[116:119]
  v_mfma_f32_16x16x32_bf16 v[116:119], a[16:19], a[48:51], v[116:119]
  v_cvt_pk_bf16_f32 v112, v112, v113
  v_cvt_pk_bf16_f32 v113, v114, v115
  v_mfma_f32_16x16x32_bf16 v[116:119], a[4:7], a[40:43], v[116:119]
  s_waitcnt lgkmcnt(2)
  ds_write_b64 v8, v[112:113] offset:0
  v_mfma_f32_16x16x32_bf16 v[120:123], a[8:11], a[40:43], v[120:123]
  v_mfma_f32_16x16x32_bf16 v[120:123], a[20:23], a[48:51], v[120:123]
  ds_read_b128 v[20:23], v0 offset:28352
  v_mfma_f32_16x16x32_bf16 v[120:123], a[32:35], a[52:55], v[120:123]
  ds_read_b128 v[24:27], v0 offset:28864
  v_mfma_f32_16x16x32_bf16 v[132:135], a[8:11], a[52:55], v[132:135]
  v_mfma_f32_16x16x32_bf16 v[132:135], a[20:23], a[44:47], v[132:135]
  v_mfma_f32_16x16x32_bf16 v[132:135], a[32:35], a[56:59], v[132:135]
  v_mfma_f32_16x16x32_bf16 v[136:139], a[0:3], a[56:59], v[136:139]
  s_waitcnt lgkmcnt(3)
  v_mfma_f32_16x16x32_bf16 v[136:139], a[12:15], v[12:15], v[136:139]
  v_cvt_pk_bf16_f32 v116, v116, v117
  v_cvt_pk_bf16_f32 v117, v118, v119
  v_mfma_f32_16x16x32_bf16 v[136:139], a[24:27], v[16:19], v[136:139]
  ds_write_b64 v8, v[116:117] offset:8
  v_mfma_f32_16x16x32_bf16 v[140:143], a[28:31], v[16:19], v[140:143]
  v_mfma_f32_16x16x32_bf16 v[140:143], a[16:19], v[12:15], v[140:143]
  ds_read_b128 a[36:39], v0 offset:29376
  v_cvt_pk_bf16_f32 v120, v120, v121
  v_mfma_f32_16x16x32_bf16 v[140:143], a[4:7], a[56:59], v[140:143]
  ds_read_b128 a[40:43], v0 offset:29888
  v_cvt_pk_bf16_f32 v121, v122, v123
  v_mfma_f32_16x16x32_bf16 v[144:147], a[8:11], a[56:59], v[144:147]
  ds_write_b64 v8, v[120:121] offset:16
  v_cvt_pk_bf16_f32 v124, v124, v125
  v_mfma_f32_16x16x32_bf16 v[144:147], a[20:23], v[12:15], v[144:147]
  v_cvt_pk_bf16_f32 v125, v126, v127
  ds_write_b64 v8, v[124:125] offset:6272
  v_mfma_f32_16x16x32_bf16 v[144:147], a[32:35], v[16:19], v[144:147]
  v_cvt_pk_bf16_f32 v128, v128, v129
  v_cvt_pk_bf16_f32 v129, v130, v131
  v_mfma_f32_16x16x32_bf16 v[148:151], a[0:3], v[16:19], v[148:151]
  s_waitcnt lgkmcnt(5)
  ds_write_b64 v8, v[128:129] offset:6280
  v_mfma_f32_16x16x32_bf16 v[148:151], a[12:15], v[20:23], v[148:151]
  v_cvt_pk_bf16_f32 v132, v132, v133
  v_cvt_pk_bf16_f32 v133, v134, v135
  v_mfma_f32_16x16x32_bf16 v[148:151], a[24:27], v[24:27], v[148:151]
  ds_write_b64 v8, v[132:133] offset:6288
L_pg5:
  s_cmp_lg_u32 s32, 0
  s_cbranch_scc1 L_pr5
  v_mfma_f32_16x16x32_bf16 v[152:155], a[28:31], v[24:27], v[152:155]
  v_mfma_f32_16x16x32_bf16 v[152:155], a[16:19], v[20:23], v[152:155]
  ds_read_b128 a[48:51], v0 offset:30400
  v_mfma_f32_16x16x32_bf16 v[152:155], a[4:7], v[16:19], v[152:155]
  ds_read_b128 a[52:55], v0 offset:30912
  v_mfma_f32_16x16x32_bf16 v[156:159], a[8:11], v[16:19], v[156:159]
  s_waitcnt lgkmcnt(2)
  s_barrier
  v_mfma_f32_16x16x32_bf16 v[156:159], a[20:23], v[20:23], v[156:159]
  v_cvt_pk_bf16_f32 v136, v136, v137
  v_cvt_pk_bf16_f32 v137, v138, v139
  v_mfma_f32_16x16x32_bf16 v[156:159], a[32:35], v[24:27], v[156:159]
  ds_write_b64 v8, v[136:137] offset:12544
  v_cvt_pk_bf16_f32 v140, v140, v141
  v_mfma_f32_16x16x32_bf16 v[160:163], a[0:3], v[24:27], v[160:163]
  v_cvt_pk_bf16_f32 v141, v142, v143
  v_mfma_f32_16x16x32_bf16 v[160:163], a[12:15], a[36:39], v[160:163]
  ds_write_b64 v8, v[140:141] offset:12552
  v_cvt_pk_bf16_f32 v144, v144, v145
  v_mfma_f32_16x16x32_bf16 v[160:163], a[24:27], a[40:43], v[160:163]
  v_cvt_pk_bf16_f32 v145, v146, v147
  ds_write_b64 v8, v[144:145] offset:12560
  v_mfma_f32_16x16x32_bf16 v[164:167], a[28:31], a[40:43], v[164:167]
  v_cvt_pk_bf16_f32 v148, v148, v149
  v_cvt_pk_bf16_f32 v149, v150, v151
  v_mfma_f32_16x16x32_bf16 v[164:167], a[16:19], a[36:39], v[164:167]
  ds_read_b128 a[44:47], v0 offset:31424
  ds_write_b64 v8, v[148:149] offset:18816
  v_mfma_f32_16x16x32_bf16 v[164:167], a[4:7], v[24:27], v[164:167]
  ds_read_b128 a[56:59], v0 offset:31936
  v_cvt_pk_bf16_f32 v152, v152, v153
  v_mfma_f32_16x16x32_bf16 v[168:171], a[8:11], v[24:27], v[168:171]
  v_cvt_pk_bf16_f32 v153, v154, v155
  ds_write_b64 v8, v[152:153] offset:18824
  v_mfma_f32_16x16x32_bf16 v[168:171], a[20:23], a[36:39], v[168:171]
  v_cvt_pk_bf16_f32 v156, v156, v157
  v_cvt_pk_bf16_f32 v157, v158, v159
  v_mfma_f32_16x16x32_bf16 v[168:171], a[32:35], a[40:43], v[168:171]
  ds_write_b64 v8, v[156:157] offset:18832
  v_mfma_f32_16x16x32_bf16 v[172:175], a[0:3], a[40:43], v[172:175]
  s_waitcnt lgkmcnt(8)
  v_mfma_f32_16x16x32_bf16 v[172:175], a[12:15], a[48:51], v[172:175]
  v_mfma_f32_16x16x32_bf16 v[172:175], a[24:27], a[52:55], v[172:175]
  v_mfma_f32_16x16x32_bf16 v[176:179], a[28:31], a[52:55], v[176:179]
  s_waitcnt lgkmcnt(0)
  s_barrier
  v_mfma_f32_16x16x32_bf16 v[176:179], a[16:19], a[48:51], v[176:179]
  v_cvt_pk_bf16_f32 v160, v160, v161
  v_cvt_pk_bf16_f32 v161, v162, v163
  v_mfma_f32_16x16x32_bf16 v[176:179], a[4:7], a[40:43], v[176:179]
  ds_write_b64 v8, v[160:161] offset:25088
  v_cvt_pk_bf16_f32 v164, v164, v165
  v_mfma_f32_16x16x32_bf16 v[180:183], a[8:11], a[40:43], v[180:183]
  v_cvt_pk_bf16_f32 v165, v166, v167
  ds_write_b64 v8, v[164:165] offset:25096
  v_mfma_f32_16x16x32_bf16 v[180:183], a[20:23], a[48:51], v[180:183]
  v_cvt_pk_bf16_f32 v168, v168, v169
  v_cvt_pk_bf16_f32 v169, v170, v171
  v_mfma_f32_16x16x32_bf16 v[180:183], a[32:35], a[52:55], v[180:183]
  ds_write_b64 v8, v[168:169] offset:25104
  v_mfma_f32_16x16x32_bf16 v[184:187], a[0:3], a[52:55], v[184:187]
  v_mfma_f32_16x16x32_bf16 v[184:187], a[12:15], a[44:47], v[184:187]
  v_cvt_pk_bf16_f32 v172, v172, v173
  v_cvt_pk_bf16_f32 v173, v174, v175
  v_mfma_f32_16x16x32_bf16 v[184:187], a[24:27], a[56:59], v[184:187]
  ds_write_b64 v8, v[172:173] offset:31360
  v_mfma_f32_16x16x32_bf16 v[188:191], a[28:31], a[56:59], v[188:191]
  v_mfma_f32_16x16x32_bf16 v[188:191], a[16:19], a[44:47], v[188:191]
  v_cvt_pk_bf16_f32 v176, v176, v177
  v_cvt_pk_bf16_f32 v177, v178, v179
  v_mfma_f32_16x16x32_bf16 v[188:191], a[4:7], a[52:55], v[188:191]
  ds_write_b64 v8, v[176:177] offset:31368
  v_mfma_f32_16x16x32_bf16 v[192:195], a[8:11], a[52:55], v[192:195]
  v_mfma_f32_16x16x32_bf16 v[192:195], a[20:23], a[44:47], v[192:195]
  v_cvt_pk_bf16_f32 v180, v180, v181
  v_cvt_pk_bf16_f32 v181, v182, v183
  v_mfma_f32_16x16x32_bf16 v[192:195], a[32:35], a[56:59], v[192:195]
  ds_write_b64 v8, v[180:181] offset:31376
  s_waitcnt lgkmcnt(0)
  s_barrier
  s_nop 7
  v_cvt_pk_bf16_f32 v184, v184, v185
  v_cvt_pk_bf16_f32 v185, v186, v187
  ds_write_b64 v8, v[184:185] offset:37632
  v_cvt_pk_bf16_f32 v188, v188, v189
  v_cvt_pk_bf16_f32 v189, v190, v191
  ds_write_b64 v8, v[188:189] offset:37640
  v_cvt_pk_bf16_f32 v192, v192, v193
  v_cvt_pk_bf16_f32 v193, v194, v195
  ds_write_b64 v8, v[192:193] offset:37648
  s_waitcnt lgkmcnt(0)
  s_barrier
  s_endpgm
L_pbody:
  s_mov_b32 s32, 1
  s_cmp_eq_u32 s39, 0
  s_cbranch_scc1 L_pg0
  s_cmp_eq_u32 s39, 96
  s_cbranch_scc1 L_pg1
  s_cmp_eq_u32 s39, 192
  s_cbranch_scc1 L_pg2
  s_branch L_pg3
L_pr0:
  s_branch L_pg4
L_pr1:
  s_branch L_pg5
L_pr2:
  s_branch L_pg6
L_pr3:
  s_branch L_pg7
L_pr4:
  s_branch L_pr7
L_pr5:
  s_branch L_pr7
L_pr6:
  s_branch L_pr7
L_pr7:
  s_mov_b32 s32, 0
  s_waitcnt vmcnt(0)
  s_add_u32 m0, s33, 33024
  s_mov_b32 s34, 24576
  buffer_load_dwordx4 v3, s[16:19], s34 offen offset:0 lds
  v_lshlrev_b32 v176, 16, v80
  v_and_b32 v177, 0xffff0000, v80
  v_lshlrev_b32 v178, 16, v81
  v_and_b32 v179, 0xffff0000, v81
  v_lshlrev_b32 v180, 16, v82
  v_and_b32 v181, 0xffff0000, v82
  buffer_load_dwordx4 v4, s[16:19], s34 offen offset:1024 lds
  v_lshlrev_b32 v182, 16, v83
  v_and_b32 v183, 0xffff0000, v83
  v_lshlrev_b32 v184, 16, v88
  v_and_b32 v185, 0xffff0000, v88
  v_lshlrev_b32 v186, 16, v89
  v_and_b32 v187, 0xffff0000, v89
  v_lshlrev_b32 v188, 16, v90
  buffer_load_dwordx4 v5, s[16:19], s34 offen offset:2048 lds
  v_and_b32 v189, 0xffff0000, v90
  v_lshlrev_b32 v190, 16, v91
  v_and_b32 v191, 0xffff0000, v91
  v_sub_f32 v36, v176, v184
  v_sub_f32 v37, v177, v185
  v_cvt_pk_bf16_f32 v160, v36, v37
  s_add_u32 m0, s33, 36096
  s_mov_b32 s34, 245760
  buffer_load_dwordx4 v3, s[16:19], s34 offen offset:0 lds
  v_sub_f32 v38, v178, v186
  v_sub_f32 v39, v179, v187
  v_cvt_pk_bf16_f32 v161, v38, v39
  v_sub_f32 v36, v180, v188
  v_sub_f32 v37, v181, v189
  v_cvt_pk_bf16_f32 v162, v36, v37
  buffer_load_dwordx4 v4, s[16:19], s34 offen offset:1024 lds
  v_sub_f32 v38, v182, v190
  v_sub_f32 v39, v183, v191
  v_cvt_pk_bf16_f32 v163, v38, v39
  v_lshlrev_b32 v176, 16, v96
  v_and_b32 v177, 0xffff0000, v96
  v_lshlrev_b32 v178, 16, v97
  buffer_load_dwordx4 v5, s[16:19], s34 offen offset:2048 lds
  v_and_b32 v179, 0xffff0000, v97
  v_lshlrev_b32 v180, 16, v98
  v_and_b32 v181, 0xffff0000, v98
  v_lshlrev_b32 v182, 16, v99
  v_and_b32 v183, 0xffff0000, v99
  v_sub_f32 v36, v184, v176
  v_sub_f32 v37, v185, v177
  s_add_u32 m0, s33, 39168
  s_mov_b32 s34, 466944
  buffer_load_dwordx4 v3, s[16:19], s34 offen offset:0 lds
  v_cvt_pk_bf16_f32 v164, v36, v37
  v_sub_f32 v38, v186, v178
  v_sub_f32 v39, v187, v179
  v_cvt_pk_bf16_f32 v165, v38, v39
  v_sub_f32 v36, v188, v180
  v_sub_f32 v37, v189, v181
  buffer_load_dwordx4 v4, s[16:19], s34 offen offset:1024 lds
  v_cvt_pk_bf16_f32 v166, v36, v37
  v_sub_f32 v38, v190, v182
  v_sub_f32 v39, v191, v183
  v_cvt_pk_bf16_f32 v167, v38, v39
  v_lshlrev_b32 v184, 16, v104
  v_and_b32 v185, 0xffff0000, v104
  buffer_load_dwordx4 v5, s[16:19], s34 offen offset:2048 lds
  v_lshlrev_b32 v186, 16, v105
  v_and_b32 v187, 0xffff0000, v105
  v_lshlrev_b32 v188, 16, v106
  v_and_b32 v189, 0xffff0000, v106
  v_lshlrev_b32 v190, 16, v107
  v_and_b32 v191, 0xffff0000, v107
  v_sub_f32 v36, v176, v184
  buffer_load_dwordx4 v[120:123], v6, s[12:15], 0 offen offset:256 nt
  v_sub_f32 v37, v177, v185
  v_cvt_pk_bf16_f32 v168, v36, v37
  v_sub_f32 v38, v178, v186
  v_sub_f32 v39, v179, v187
  v_cvt_pk_bf16_f32 v169, v38, v39
  v_sub_f32 v36, v180, v188
  buffer_load_dwordx4 v[128:131], v7, s[12:15], 0 offen offset:640 nt
  v_sub_f32 v37, v181, v189
  v_cvt_pk_bf16_f32 v170, v36, v37
  v_sub_f32 v38, v182, v190
  v_sub_f32 v39, v183, v191
  v_cvt_pk_bf16_f32 v171, v38, v39
  v_lshlrev_b32 v176, 16, v112
  buffer_load_dwordx4 v[136:139], v7, s[12:15], 0 offen offset:1408 nt
  v_and_b32 v177, 0xffff0000, v112
  v_lshlrev_b32 v178, 16, v113
  v_and_b32 v179, 0xffff0000, v113
  v_lshlrev_b32 v180, 16, v114
  v_and_b32 v181, 0xffff0000, v114
  v_lshlrev_b32 v182, 16, v115
  buffer_load_dwordx4 v[144:147], v7, s[12:15], 0 offen offset:2176 nt
  v_and_b32 v183, 0xffff0000, v115
  v_sub_f32 v36, v184, v176
  v_sub_f32 v37, v185, v177
  v_cvt_pk_bf16_f32 v172, v36, v37
  v_sub_f32 v38, v186, v178
  v_sub_f32 v39, v187, v179
  v_cvt_pk_bf16_f32 v173, v38, v39
  buffer_load_dwordx4 v[152:155], v7, s[12:15], 0 offen offset:2944 nt
  v_sub_f32 v36, v188, v180
  v_sub_f32 v37, v189, v181
  v_cvt_pk_bf16_f32 v174, v36, v37
  v_sub_f32 v38, v190, v182
  v_sub_f32 v39, v191, v183
  v_cvt_pk_bf16_f32 v175, v38, v39
  ds_write_b128 v9, v[160:163] offset:16512
  ds_write_b128 v9, v[164:167] offset:16576
  ds_write_b128 v9, v[168:171] offset:16640
  ds_write_b128 v9, v[172:175] offset:16704
  s_barrier
  s_add_u32 m0, s33, 106752
  s_mov_b32 s34, 36864
  buffer_load_dwordx4 v3, s[16:19], s34 offen offset:0 lds
  buffer_load_dwordx4 v4, s[16:19], s34 offen offset:1024 lds
  buffer_load_dwordx4 v5, s[16:19], s34 offen offset:2048 lds
  s_add_u32 m0, s33, 109824
  s_mov_b32 s34, 258048
  buffer_load_dwordx4 v3, s[16:19], s34 offen offset:0 lds
  buffer_load_dwordx4 v4, s[16:19], s34 offen offset:1024 lds
  s_waitcnt vmcnt(10) lgkmcnt(0)
  s_barrier
  s_add_u32 m0, s33, 109824
  s_mov_b32 s34, 258048
  buffer_load_dwordx4 v5, s[16:19], s34 offen offset:2048 lds
  s_add_u32 m0, s33, 112896
  s_mov_b32 s34, 479232
  buffer_load_dwordx4 v3, s[16:19], s34 offen offset:0 lds
  buffer_load_dwordx4 v4, s[16:19], s34 offen offset:1024 lds
  buffer_load_dwordx4 v5, s[16:19], s34 offen offset:2048 lds
  s_add_u32 m0, s33, 69888
  s_mov_b32 s34, 49152
  buffer_load_dwordx4 v3, s[16:19], s34 offen offset:0 lds
  buffer_load_dwordx4 v4, s[16:19], s34 offen offset:1024 lds
  buffer_load_dwordx4 v5, s[16:19], s34 offen offset:2048 lds
  s_add_u32 m0, s33, 72960
  s_mov_b32 s34, 270336
  buffer_load_dwordx4 v3, s[16:19], s34 offen offset:0 lds
  buffer_load_dwordx4 v4, s[16:19], s34 offen offset:1024 lds
  buffer_load_dwordx4 v5, s[16:19], s34 offen offset:2048 lds
  s_add_u32 m0, s33, 76032
  s_mov_b32 s34, 491520
  buffer_load_dwordx4 v3, s[16:19], s34 offen offset:0 lds
  buffer_load_dwordx4 v4, s[16:19], s34 offen offset:1024 lds
  buffer_load_dwordx4 v5, s[16:19], s34 offen offset:2048 lds
  s_waitcnt vmcnt(18)
  v_lshlrev_b32 v176, 16, v120
  v_and_b32 v177, 0xffff0000, v120
  v_lshlrev_b32 v178, 16, v121
  v_and_b32 v179, 0xffff0000, v121
  v_lshlrev_b32 v180, 16, v122
  v_and_b32 v181, 0xffff0000, v122
  v_lshlrev_b32 v182, 16, v123
  v_and_b32 v183, 0xffff0000, v123
  v_lshlrev_b32 v184, 16, v128
  v_and_b32 v185, 0xffff0000, v128
  v_lshlrev_b32 v186, 16, v129
  v_and_b32 v187, 0xffff0000, v129
  v_lshlrev_b32 v188, 16, v130
  v_and_b32 v189, 0xffff0000, v130
  v_lshlrev_b32 v190, 16, v131
  v_and_b32 v191, 0xffff0000, v131
  v_sub_f32 v36, v176, v184
  v_sub_f32 v37, v177, v185
  v_cvt_pk_bf16_f32 v20, v36, v37
  v_sub_f32 v38, v178, v186
  v_sub_f32 v39, v179, v187
  v_cvt_pk_bf16_f32 v21, v38, v39
  v_sub_f32 v36, v180, v188
  v_sub_f32 v37, v181, v189
  v_cvt_pk_bf16_f32 v22, v36, v37
  v_sub_f32 v38, v182, v190
  v_sub_f32 v39, v183, v191
  v_cvt_pk_bf16_f32 v23, v38, v39
  v_lshlrev_b32 v176, 16, v136
  v_and_b32 v177, 0xffff0000, v136
  v_lshlrev_b32 v178, 16, v137
  v_and_b32 v179, 0xffff0000, v137
  v_lshlrev_b32 v180, 16, v138
  v_and_b32 v181, 0xffff0000, v138
  v_lshlrev_b32 v182, 16, v139
  v_and_b32 v183, 0xffff0000, v139
  v_sub_f32 v36, v184, v176
  v_sub_f32 v37, v185, v177
  v_cvt_pk_bf16_f32 v24, v36, v37
  v_sub_f32 v38, v186, v178
  v_sub_f32 v39, v187, v179
  v_cvt_pk_bf16_f32 v25, v38, v39
  v_sub_f32 v36, v188, v180
  v_sub_f32 v37, v189, v181
  s_waitcnt vmcnt(9)
  s_barrier
  buffer_load_dwordx4 v[44:47], v7, s[12:15], 0 offen offset:0 nt
  v_cvt_pk_bf16_f32 v26, v36, v37
  v_sub_f32 v38, v190, v182
  v_sub_f32 v39, v191, v183
  v_cvt_pk_bf16_f32 v27, v38, v39
  v_lshlrev_b32 v184, 16, v144
  v_and_b32 v185, 0xffff0000, v144
  v_lshlrev_b32 v186, 16, v145
  v_and_b32 v187, 0xffff0000, v145
  v_lshlrev_b32 v188, 16, v146
  v_and_b32 v189, 0xffff0000, v146
  v_lshlrev_b32 v190, 16, v147
  buffer_load_dwordx4 v[52:55], v7, s[12:15], 0 offen offset:768 nt
  v_and_b32 v191, 0xffff0000, v147
  v_sub_f32 v36, v176, v184
  v_sub_f32 v37, v177, v185
  v_cvt_pk_bf16_f32 v28, v36, v37
  v_sub_f32 v38, v178, v186
  v_sub_f32 v39, v179, v187
  v_cvt_pk_bf16_f32 v29, v38, v39
  v_sub_f32 v36, v180, v188
  v_sub_f32 v37, v181, v189
  v_cvt_pk_bf16_f32 v30, v36, v37
  v_sub_f32 v38, v182, v190
  buffer_load_dwordx4 v[60:63], v7, s[12:15], 0 offen offset:1536 nt
  v_sub_f32 v39, v183, v191
  v_cvt_pk_bf16_f32 v31, v38, v39
  v_lshlrev_b32 v176, 16, v152
  v_and_b32 v177, 0xffff0000, v152
  v_lshlrev_b32 v178, 16, v153
  v_and_b32 v179, 0xffff0000, v153
  v_lshlrev_b32 v180, 16, v154
  v_and_b32 v181, 0xffff0000, v154
  v_lshlrev_b32 v182, 16, v155
  v_and_b32 v183, 0xffff0000, v155
  v_sub_f32 v36, v184, v176
  buffer_load_dwordx4 v[68:71], v7, s[12:15], 0 offen offset:2304 nt
  v_sub_f32 v37, v185, v177
  v_cvt_pk_bf16_f32 v32, v36, v37
  v_sub_f32 v38, v186, v178
  v_sub_f32 v39, v187, v179
  v_cvt_pk_bf16_f32 v33, v38, v39
  v_sub_f32 v36, v188, v180
  v_sub_f32 v37, v189, v181
  v_cvt_pk_bf16_f32 v34, v36, v37
  v_sub_f32 v38, v190, v182
  v_sub_f32 v39, v191, v183
  v_cvt_pk_bf16_f32 v35, v38, v39
  s_barrier
  ds_write_b128 v9, v[20:23] offset:0
  ds_write_b128 v9, v[24:27] offset:64
  ds_write_b128 v9, v[28:31] offset:128
  ds_write_b128 v9, v[32:35] offset:192
  s_add_u32 m0, s33, 33024
  s_mov_b32 s34, 61440
  buffer_load_dwordx4 v3, s[16:19], s34 offen offset:0 lds
  buffer_load_dwordx4 v4, s[16:19], s34 offen offset:1024 lds
  buffer_load_dwordx4 v5, s[16:19], s34 offen offset:2048 lds
  s_waitcnt vmcnt(7) lgkmcnt(0)
  s_barrier
  s_add_u32 m0, s33, 36096
  s_mov_b32 s34, 282624
  buffer_load_dwordx4 v3, s[16:19], s34 offen offset:0 lds
  buffer_load_dwordx4 v4, s[16:19], s34 offen offset:1024 lds
  buffer_load_dwordx4 v5, s[16:19], s34 offen offset:2048 lds
  s_add_u32 m0, s33, 39168
  s_mov_b32 s34, 503808
  buffer_load_dwordx4 v3, s[16:19], s34 offen offset:0 lds
  buffer_load_dwordx4 v4, s[16:19], s34 offen offset:1024 lds
  buffer_load_dwordx4 v5, s[16:19], s34 offen offset:2048 lds
  v_and_b32 v17, 31, v1
  v_lshlrev_b32 v17, 2, v17
  buffer_load_dword v16, v17, s[48:51], 0 offen sc1
  s_waitcnt vmcnt(10)
  v_lshlrev_b32 v176, 16, v44
  v_and_b32 v177, 0xffff0000, v44
  v_lshlrev_b32 v178, 16, v45
  v_and_b32 v179, 0xffff0000, v45
  v_lshlrev_b32 v180, 16, v46
  v_and_b32 v181, 0xffff0000, v46
  v_lshlrev_b32 v182, 16, v47
  v_and_b32 v183, 0xffff0000, v47
  v_lshlrev_b32 v184, 16, v48
  v_and_b32 v185, 0xffff0000, v48
  v_lshlrev_b32 v186, 16, v49
  v_and_b32 v187, 0xffff0000, v49
  v_lshlrev_b32 v188, 16, v50
  v_and_b32 v189, 0xffff0000, v50
  v_lshlrev_b32 v190, 16, v51
  v_and_b32 v191, 0xffff0000, v51
  v_add_f32 v36, v176, v184
  v_add_f32 v37, v177, v185
  v_cvt_pk_bf16_f32 v48, v36, v37
  v_add_f32 v38, v178, v186
  v_add_f32 v39, v179, v187
  v_cvt_pk_bf16_f32 v49, v38, v39
  v_add_f32 v36, v180, v188
  v_add_f32 v37, v181, v189
  v_cvt_pk_bf16_f32 v50, v36, v37
  v_add_f32 v38, v182, v190
  v_add_f32 v39, v183, v191
  v_cvt_pk_bf16_f32 v51, v38, v39
  v_sub_f32 v36, v184, v176
  v_sub_f32 v37, v185, v177
  v_cvt_pk_bf16_f32 v160, v36, v37
  v_sub_f32 v38, v186, v178
  v_sub_f32 v39, v187, v179
  v_cvt_pk_bf16_f32 v161, v38, v39
  v_sub_f32 v36, v188, v180
  v_sub_f32 v37, v189, v181
  v_cvt_pk_bf16_f32 v162, v36, v37
  v_sub_f32 v38, v190, v182
  v_sub_f32 v39, v191, v183
  v_cvt_pk_bf16_f32 v163, v38, v39
  v_lshlrev_b32 v176, 16, v52
  v_and_b32 v177, 0xffff0000, v52
  v_lshlrev_b32 v178, 16, v53
  v_and_b32 v179, 0xffff0000, v53
  v_lshlrev_b32 v180, 16, v54
  v_and_b32 v181, 0xffff0000, v54
  v_lshlrev_b32 v182, 16, v55
  v_and_b32 v183, 0xffff0000, v55
  v_lshlrev_b32 v184, 16, v56
  v_and_b32 v185, 0xffff0000, v56
  v_lshlrev_b32 v186, 16, v57
  v_and_b32 v187, 0xffff0000, v57
  v_lshlrev_b32 v188, 16, v58
  s_waitcnt vmcnt(0)
  s_mov_b32 s36, 0
L_poll:
  v_cmp_ne_u32 vcc, 0, v16
  s_nop 1
  s_cmp_eq_u64 vcc, exec
  s_cbranch_scc1 L_pollok
  s_add_u32 s36, s36, 1
  s_cmp_ge_u32 s36, 0x100000
  s_cbranch_scc1 L_pollok
  s_sleep 4
  buffer_load_dword v16, v17, s[48:51], 0 offen sc1
  s_waitcnt vmcnt(0)
  s_branch L_poll
L_pollok:
  v_and_b32 v189, 0xffff0000, v58
  v_lshlrev_b32 v190, 16, v59
  v_and_b32 v191, 0xffff0000, v59
  v_add_f32 v36, v176, v184
  v_add_f32 v37, v177, v185
  s_add_u32 m0, s33, 106752
  s_mov_b32 s34, 221184
  buffer_load_dwordx4 v18, s[44:47], s34 offen offset:0 sc1 lds
  v_cvt_pk_bf16_f32 v56, v36, v37
  v_add_f32 v38, v178, v186
  v_add_f32 v39, v179, v187
  v_cvt_pk_bf16_f32 v57, v38, v39
  v_add_f32 v36, v180, v188
  v_add_f32 v37, v181, v189
  buffer_load_dwordx4 v18, s[44:47], s34 offen offset:1024 sc1 lds
  v_cvt_pk_bf16_f32 v58, v36, v37
  v_add_f32 v38, v182, v190
  v_add_f32 v39, v183, v191
  v_cvt_pk_bf16_f32 v59, v38, v39
  v_sub_f32 v36, v184, v176
  buffer_load_dwordx4 v18, s[44:47], s34 offen offset:2048 sc1 lds
  v_sub_f32 v37, v185, v177
  v_cvt_pk_bf16_f32 v164, v36, v37
  v_sub_f32 v38, v186, v178
  v_sub_f32 v39, v187, v179
  v_cvt_pk_bf16_f32 v165, v38, v39
  s_add_u32 m0, s33, 109824
  s_mov_b32 s34, 294912
  buffer_load_dwordx4 v18, s[44:47], s34 offen offset:0 sc1 lds
  v_sub_f32 v36, v188, v180
  v_sub_f32 v37, v189, v181
  v_cvt_pk_bf16_f32 v166, v36, v37
  v_sub_f32 v38, v190, v182
  v_sub_f32 v39, v191, v183
  buffer_load_dwordx4 v18, s[44:47], s34 offen offset:1024 sc1 lds
  v_cvt_pk_bf16_f32 v167, v38, v39
  v_lshlrev_b32 v176, 16, v60
  v_and_b32 v177, 0xffff0000, v60
  v_lshlrev_b32 v178, 16, v61
  v_and_b32 v179, 0xffff0000, v61
  v_lshlrev_b32 v180, 16, v62
  buffer_load_dwordx4 v18, s[44:47], s34 offen offset:2048 sc1 lds
  v_and_b32 v181, 0xffff0000, v62
  v_lshlrev_b32 v182, 16, v63
  v_and_b32 v183, 0xffff0000, v63
  v_lshlrev_b32 v184, 16, v64
  v_and_b32 v185, 0xffff0000, v64
  s_add_u32 m0, s33, 112896
  s_mov_b32 s34, 368640
  buffer_load_dwordx4 v18, s[44:47], s34 offen offset:0 sc1 lds
  v_lshlrev_b32 v186, 16, v65
  v_and_b32 v187, 0xffff0000, v65
  v_lshlrev_b32 v188, 16, v66
  v_and_b32 v189, 0xffff0000, v66
  v_lshlrev_b32 v190, 16, v67
  buffer_load_dwordx4 v18, s[44:47], s34 offen offset:1024 sc1 lds
  v_and_b32 v191, 0xffff0000, v67
  v_add_f32 v36, v176, v184
  v_add_f32 v37, v177, v185
  v_cvt_pk_bf16_f32 v64, v36, v37
  v_add_f32 v38, v178, v186
  v_add_f32 v39, v179, v187
  buffer_load_dwordx4 v18, s[44:47], s34 offen offset:2048 sc1 lds
  v_cvt_pk_bf16_f32 v65, v38, v39
  v_add_f32 v36, v180, v188
  v_add_f32 v37, v181, v189
  v_cvt_pk_bf16_f32 v66, v36, v37
  v_add_f32 v38, v182, v190
  s_barrier
  buffer_load_dwordx4 v[84:87], v7, s[12:15], 0 offen offset:128 nt
  v_add_f32 v39, v183, v191
  v_cvt_pk_bf16_f32 v67, v38, v39
  v_sub_f32 v36, v184, v176
  v_sub_f32 v37, v185, v177
  v_cvt_pk_bf16_f32 v168, v36, v37
  v_sub_f32 v38, v186, v178
  v_sub_f32 v39, v187, v179
  v_cvt_pk_bf16_f32 v169, v38, v39
  v_sub_f32 v36, v188, v180
  v_sub_f32 v37, v189, v181
  v_cvt_pk_bf16_f32 v170, v36, v37
  v_sub_f32 v38, v190, v182
  v_sub_f32 v39, v191, v183
  buffer_load_dwordx4 v[92:95], v7, s[12:15], 0 offen offset:896 nt
  v_cvt_pk_bf16_f32 v171, v38, v39
  v_lshlrev_b32 v176, 16, v68
  v_and_b32 v177, 0xffff0000, v68
  v_lshlrev_b32 v178, 16, v69
  v_and_b32 v179, 0xffff0000, v69
  v_lshlrev_b32 v180, 16, v70
  v_and_b32 v181, 0xffff0000, v70
  v_lshlrev_b32 v182, 16, v71
  v_and_b32 v183, 0xffff0000, v71
  v_lshlrev_b32 v184, 16, v72
  v_and_b32 v185, 0xffff0000, v72
  v_lshlrev_b32 v186, 16, v73
  v_and_b32 v187, 0xffff0000, v73
  v_lshlrev_b32 v188, 16, v74
  buffer_load_dwordx4 v[100:103], v7, s[12:15], 0 offen offset:1664 nt
  v_and_b32 v189, 0xffff0000, v74
  v_lshlrev_b32 v190, 16, v75
  v_and_b32 v191, 0xffff0000, v75
  v_add_f32 v36, v176, v184
  v_add_f32 v37, v177, v185
  v_cvt_pk_bf16_f32 v72, v36, v37
  v_add_f32 v38, v178, v186
  v_add_f32 v39, v179, v187
  v_cvt_pk_bf16_f32 v73, v38, v39
  v_add_f32 v36, v180, v188
  v_add_f32 v37, v181, v189
  v_cvt_pk_bf16_f32 v74, v36, v37
  v_add_f32 v38, v182, v190
  buffer_load_dwordx4 v[108:111], v7, s[12:15], 0 offen offset:2432 nt
  v_add_f32 v39, v183, v191
  v_cvt_pk_bf16_f32 v75, v38, v39
  v_sub_f32 v36, v184, v176
  v_sub_f32 v37, v185, v177
  v_cvt_pk_bf16_f32 v172, v36, v37
  v_sub_f32 v38, v186, v178
  v_sub_f32 v39, v187, v179
  v_cvt_pk_bf16_f32 v173, v38, v39
  v_sub_f32 v36, v188, v180
  v_sub_f32 v37, v189, v181
  v_cvt_pk_bf16_f32 v174, v36, v37
  v_sub_f32 v38, v190, v182
  v_sub_f32 v39, v191, v183
  v_cvt_pk_bf16_f32 v175, v38, v39
  s_barrier
  ds_write_b128 v9, v[160:163] offset:16512
  ds_write_b128 v9, v[164:167] offset:16576
  ds_write_b128 v9, v[168:171] offset:16640
  ds_write_b128 v9, v[172:175] offset:16704
  s_add_u32 m0, s33, 69888
  s_mov_b32 s34, 233472
  buffer_load_dwordx4 v18, s[44:47], s34 offen offset:0 sc1 lds
  buffer_load_dwordx4 v18, s[44:47], s34 offen offset:1024 sc1 lds
  buffer_load_dwordx4 v18, s[44:47], s34 offen offset:2048 sc1 lds
  s_waitcnt vmcnt(7) lgkmcnt(0)
  s_barrier
  s_add_u32 m0, s33, 72960
  s_mov_b32 s34, 307200
  buffer_load_dwordx4 v18, s[44:47], s34 offen offset:0 sc1 lds
  buffer_load_dwordx4 v18, s[44:47], s34 offen offset:1024 sc1 lds
  buffer_load_dwordx4 v18, s[44:47], s34 offen offset:2048 sc1 lds
  s_add_u32 m0, s33, 76032
  s_mov_b32 s34, 380928
  buffer_load_dwordx4 v18, s[44:47], s34 offen offset:0 sc1 lds
  buffer_load_dwordx4 v18, s[44:47], s34 offen offset:1024 sc1 lds
  buffer_load_dwordx4 v18, s[44:47], s34 offen offset:2048 sc1 lds
  s_waitcnt vmcnt(9)
  s_add_u32 m0, s33, 33024
  s_mov_b32 s34, 0
  buffer_load_dwordx4 v18, s[44:47], s34 offen offset:0 sc1 lds
  v_lshlrev_b32 v176, 16, v84
  v_and_b32 v177, 0xffff0000, v84
  v_lshlrev_b32 v178, 16, v85
  v_and_b32 v179, 0xffff0000, v85
  v_lshlrev_b32 v180, 16, v86
  v_and_b32 v181, 0xffff0000, v86
  buffer_load_dwordx4 v18, s[44:47], s34 offen offset:1024 sc1 lds
  v_lshlrev_b32 v182, 16, v87
  v_and_b32 v183, 0xffff0000, v87
  v_lshlrev_b32 v184, 16, v88
  v_and_b32 v185, 0xffff0000, v88
  v_lshlrev_b32 v186, 16, v89
  v_and_b32 v187, 0xffff0000, v89
  buffer_load_dwordx4 v18, s[44:47], s34 offen offset:2048 sc1 lds
  v_lshlrev_b32 v188, 16, v90
  v_and_b32 v189, 0xffff0000, v90
  v_lshlrev_b32 v190, 16, v91
  v_and_b32 v191, 0xffff0000, v91
  v_add_f32 v36, v176, v184
  v_add_f32 v37, v177, v185
  s_add_u32 m0, s33, 36096
  s_mov_b32 s34, 73728
  buffer_load_dwordx4 v18, s[44:47], s34 offen offset:0 sc1 lds
  v_cvt_pk_bf16_f32 v88, v36, v37
  v_add_f32 v38, v178, v186
  v_add_f32 v39, v179, v187
  v_cvt_pk_bf16_f32 v89, v38, v39
  v_add_f32 v36, v180, v188
  v_add_f32 v37, v181, v189
  buffer_load_dwordx4 v18, s[44:47], s34 offen offset:1024 sc1 lds
  v_cvt_pk_bf16_f32 v90, v36, v37
  v_add_f32 v38, v182, v190
  v_add_f32 v39, v183, v191
  v_cvt_pk_bf16_f32 v91, v38, v39
  v_sub_f32 v36, v184, v176
  buffer_load_dwordx4 v18, s[44:47], s34 offen offset:2048 sc1 lds
  v_sub_f32 v37, v185, v177
  v_cvt_pk_bf16_f32 v20, v36, v37
  v_sub_f32 v38, v186, v178
  v_sub_f32 v39, v187, v179
  v_cvt_pk_bf16_f32 v21, v38, v39
  v_sub_f32 v36, v188, v180
  s_add_u32 m0, s33, 39168
  s_mov_b32 s34, 147456
  buffer_load_dwordx4 v18, s[44:47], s34 offen offset:0 sc1 lds
  v_sub_f32 v37, v189, v181
  v_cvt_pk_bf16_f32 v22, v36, v37
  v_sub_f32 v38, v190, v182
  v_sub_f32 v39, v191, v183
  v_cvt_pk_bf16_f32 v23, v38, v39
  v_lshlrev_b32 v176, 16, v92
  buffer_load_dwordx4 v18, s[44:47], s34 offen offset:1024 sc1 lds
  v_and_b32 v177, 0xffff0000, v92
  s_branch L_po6
L_pg6:
  s_branch L_pr6
L_po6:
  v_lshlrev_b32 v178, 16, v93
  v_and_b32 v179, 0xffff0000, v93
  v_lshlrev_b32 v180, 16, v94
  v_and_b32 v181, 0xffff0000, v94
  v_lshlrev_b32 v182, 16, v95
  buffer_load_dwordx4 v18, s[44:47], s34 offen offset:2048 sc1 lds
  v_and_b32 v183, 0xffff0000, v95
  v_lshlrev_b32 v184, 16, v96
  v_and_b32 v185, 0xffff0000, v96
  v_lshlrev_b32 v186, 16, v97
  v_and_b32 v187, 0xffff0000, v97
  v_lshlrev_b32 v188, 16, v98
  s_waitcnt vmcnt(9)
  s_barrier
  buffer_load_dwordx4 v[124:127], v7, s[12:15], 0 offen offset:256 nt
  v_and_b32 v189, 0xffff0000, v98
  v_lshlrev_b32 v190, 16, v99
  v_and_b32 v191, 0xffff0000, v99
  v_add_f32 v36, v176, v184
  v_add_f32 v37, v177, v185
  v_cvt_pk_bf16_f32 v96, v36, v37
  v_add_f32 v38, v178, v186
  v_add_f32 v39, v179, v187
  buffer_load_dwordx4 v[132:135], v7, s[12:15], 0 offen offset:1024 nt
  v_cvt_pk_bf16_f32 v97, v38, v39
  v_add_f32 v36, v180, v188
  v_add_f32 v37, v181, v189
  v_cvt_pk_bf16_f32 v98, v36, v37
  v_add_f32 v38, v182, v190
  v_add_f32 v39, v183, v191
  v_cvt_pk_bf16_f32 v99, v38, v39
  buffer_load_dwordx4 v[140:143], v7, s[12:15], 0 offen offset:1792 nt
  v_sub_f32 v36, v184, v176
  v_sub_f32 v37, v185, v177
  v_cvt_pk_bf16_f32 v24, v36, v37
  v_sub_f32 v38, v186, v178
  v_sub_f32 v39, v187, v179
  v_cvt_pk_bf16_f32 v25, v38, v39
  v_sub_f32 v36, v188, v180
  v_sub_f32 v37, v189, v181
  buffer_load_dwordx4 v[148:151], v7, s[12:15], 0 offen offset:2560 nt
  v_cvt_pk_bf16_f32 v26, v36, v37
  v_sub_f32 v38, v190, v182
  v_sub_f32 v39, v191, v183
  v_cvt_pk_bf16_f32 v27, v38, v39
  v_lshlrev_b32 v176, 16, v100
  v_and_b32 v177, 0xffff0000, v100
  v_lshlrev_b32 v178, 16, v101
  buffer_load_dwordx4 v[76:79], v8, s[12:15], 0 offen offset:0 nt
  v_and_b32 v179, 0xffff0000, v101
  v_lshlrev_b32 v180, 16, v102
  v_and_b32 v181, 0xffff0000, v102
  v_lshlrev_b32 v182, 16, v103
  v_and_b32 v183, 0xffff0000, v103
  v_lshlrev_b32 v184, 16, v104
  v_and_b32 v185, 0xffff0000, v104
  v_lshlrev_b32 v186, 16, v105
  buffer_load_dwordx4 v[116:119], v8, s[12:15], 0 offen offset:128 nt
  v_and_b32 v187, 0xffff0000, v105
  v_lshlrev_b32 v188, 16, v106
  v_and_b32 v189, 0xffff0000, v106
  v_lshlrev_b32 v190, 16, v107
  v_and_b32 v191, 0xffff0000, v107
  v_add_f32 v36, v176, v184
  v_add_f32 v37, v177, v185
  buffer_load_dwordx4 v[156:159], v8, s[12:15], 0 offen offset:256 nt
  v_cvt_pk_bf16_f32 v104, v36, v37
  v_add_f32 v38, v178, v186
  v_add_f32 v39, v179, v187
  v_cvt_pk_bf16_f32 v105, v38, v39
  v_add_f32 v36, v180, v188
  v_add_f32 v37, v181, v189
  v_cvt_pk_bf16_f32 v106, v36, v37
  v_add_f32 v38, v182, v190
  s_barrier
  ds_write_b128 v9, v[48:51] offset:0
  ds_write_b128 v9, v[56:59] offset:64
  ds_write_b128 v9, v[64:67] offset:128
  ds_write_b128 v9, v[72:75] offset:192
  s_add_u32 m0, s33, 106752
  s_mov_b32 s34, 12288
  buffer_load_dwordx4 v18, s[44:47], s34 offen offset:0 sc1 lds
  buffer_load_dwordx4 v18, s[44:47], s34 offen offset:1024 sc1 lds
  buffer_load_dwordx4 v18, s[44:47], s34 offen offset:2048 sc1 lds
  s_waitcnt vmcnt(10) lgkmcnt(0)
  s_barrier
  s_add_u32 m0, s33, 109824
  s_mov_b32 s34, 86016
  buffer_load_dwordx4 v18, s[44:47], s34 offen offset:0 sc1 lds
  v_add_f32 v39, v183, v191
  v_cvt_pk_bf16_f32 v107, v38, v39
  v_sub_f32 v36, v184, v176
  v_sub_f32 v37, v185, v177
  buffer_load_dwordx4 v18, s[44:47], s34 offen offset:1024 sc1 lds
  v_cvt_pk_bf16_f32 v28, v36, v37
  v_sub_f32 v38, v186, v178
  v_sub_f32 v39, v187, v179
  buffer_load_dwordx4 v18, s[44:47], s34 offen offset:2048 sc1 lds
  v_cvt_pk_bf16_f32 v29, v38, v39
  v_sub_f32 v36, v188, v180
  v_sub_f32 v37, v189, v181
  v_cvt_pk_bf16_f32 v30, v36, v37
  s_add_u32 m0, s33, 112896
  s_mov_b32 s34, 159744
  buffer_load_dwordx4 v18, s[44:47], s34 offen offset:0 sc1 lds
  v_sub_f32 v38, v190, v182
  v_sub_f32 v39, v191, v183
  v_cvt_pk_bf16_f32 v31, v38, v39
  buffer_load_dwordx4 v18, s[44:47], s34 offen offset:1024 sc1 lds
  v_lshlrev_b32 v176, 16, v108
  v_and_b32 v177, 0xffff0000, v108
  v_lshlrev_b32 v178, 16, v109
  v_and_b32 v179, 0xffff0000, v109
  buffer_load_dwordx4 v18, s[44:47], s34 offen offset:2048 sc1 lds
  v_lshlrev_b32 v180, 16, v110
  v_and_b32 v181, 0xffff0000, v110
  v_lshlrev_b32 v182, 16, v111
  v_and_b32 v183, 0xffff0000, v111
  s_add_u32 m0, s33, 69888
  s_mov_b32 s34, 245760
  buffer_load_dwordx4 v18, s[44:47], s34 offen offset:0 sc1 lds
  v_lshlrev_b32 v184, 16, v112
  v_and_b32 v185, 0xffff0000, v112
  v_lshlrev_b32 v186, 16, v113
  buffer_load_dwordx4 v18, s[44:47], s34 offen offset:1024 sc1 lds
  v_and_b32 v187, 0xffff0000, v113
  v_lshlrev_b32 v188, 16, v114
  v_and_b32 v189, 0xffff0000, v114
  v_lshlrev_b32 v190, 16, v115
  buffer_load_dwordx4 v18, s[44:47], s34 offen offset:2048 sc1 lds
  v_and_b32 v191, 0xffff0000, v115
  v_add_f32 v36, v176, v184
  v_add_f32 v37, v177, v185
  s_add_u32 m0, s33, 72960
  s_mov_b32 s34, 319488
  buffer_load_dwordx4 v18, s[44:47], s34 offen offset:0 sc1 lds
  v_cvt_pk_bf16_f32 v112, v36, v37
  v_add_f32 v38, v178, v186
  v_add_f32 v39, v179, v187
  v_cvt_pk_bf16_f32 v113, v38, v39
  buffer_load_dwordx4 v18, s[44:47], s34 offen offset:1024 sc1 lds
  v_add_f32 v36, v180, v188
  v_add_f32 v37, v181, v189
  v_cvt_pk_bf16_f32 v114, v36, v37
  v_add_f32 v38, v182, v190
  buffer_load_dwordx4 v18, s[44:47], s34 offen offset:2048 sc1 lds
  v_add_f32 v39, v183, v191
  v_cvt_pk_bf16_f32 v115, v38, v39
  v_sub_f32 v36, v184, v176
  s_add_u32 m0, s33, 76032
  s_mov_b32 s34, 393216
  buffer_load_dwordx4 v18, s[44:47], s34 offen offset:0 sc1 lds
  v_sub_f32 v37, v185, v177
  v_cvt_pk_bf16_f32 v32, v36, v37
  v_sub_f32 v38, v186, v178
  v_sub_f32 v39, v187, v179
  buffer_load_dwordx4 v18, s[44:47], s34 offen offset:1024 sc1 lds
  v_cvt_pk_bf16_f32 v33, v38, v39
  v_sub_f32 v36, v188, v180
  v_sub_f32 v37, v189, v181
  buffer_load_dwordx4 v18, s[44:47], s34 offen offset:2048 sc1 lds
  v_cvt_pk_bf16_f32 v34, v36, v37
  v_sub_f32 v38, v190, v182
  v_sub_f32 v39, v191, v183
  v_cvt_pk_bf16_f32 v35, v38, v39
  s_waitcnt vmcnt(9)
  s_barrier
  v_lshlrev_b32 v176, 16, v124
  v_and_b32 v177, 0xffff0000, v124
  v_lshlrev_b32 v178, 16, v125
  v_and_b32 v179, 0xffff0000, v125
  v_lshlrev_b32 v180, 16, v126
  v_and_b32 v181, 0xffff0000, v126
  v_lshlrev_b32 v182, 16, v127
  v_and_b32 v183, 0xffff0000, v127
  v_lshlrev_b32 v184, 16, v128
  v_and_b32 v185, 0xffff0000, v128
  v_lshlrev_b32 v186, 16, v129
  v_and_b32 v187, 0xffff0000, v129
  v_lshlrev_b32 v188, 16, v130
  v_and_b32 v189, 0xffff0000, v130
  v_lshlrev_b32 v190, 16, v131
  v_and_b32 v191, 0xffff0000, v131
  v_add_f32 v36, v176, v184
  v_add_f32 v37, v177, v185
  v_cvt_pk_bf16_f32 v160, v36, v37
  v_add_f32 v38, v178, v186
  v_add_f32 v39, v179, v187
  v_cvt_pk_bf16_f32 v161, v38, v39
  v_add_f32 v36, v180, v188
  v_add_f32 v37, v181, v189
  v_cvt_pk_bf16_f32 v162, v36, v37
  v_add_f32 v38, v182, v190
  v_add_f32 v39, v183, v191
  v_cvt_pk_bf16_f32 v163, v38, v39
  v_sub_f32 v36, v184, v176
  v_sub_f32 v37, v185, v177
  v_cvt_pk_bf16_f32 v128, v36, v37
  v_sub_f32 v38, v186, v178
  v_sub_f32 v39, v187, v179
  v_cvt_pk_bf16_f32 v129, v38, v39
  v_sub_f32 v36, v188, v180
  v_sub_f32 v37, v189, v181
  v_cvt_pk_bf16_f32 v130, v36, v37
  v_sub_f32 v38, v190, v182
  v_sub_f32 v39, v191, v183
  v_cvt_pk_bf16_f32 v131, v38, v39
  v_lshlrev_b32 v176, 16, v132
  v_and_b32 v177, 0xffff0000, v132
  v_lshlrev_b32 v178, 16, v133
  v_and_b32 v179, 0xffff0000, v133
  v_lshlrev_b32 v180, 16, v134
  v_and_b32 v181, 0xffff0000, v134
  v_lshlrev_b32 v182, 16, v135
  v_and_b32 v183, 0xffff0000, v135
  v_lshlrev_b32 v184, 16, v136
  v_and_b32 v185, 0xffff0000, v136
  v_lshlrev_b32 v186, 16, v137
  v_and_b32 v187, 0xffff0000, v137
  v_lshlrev_b32 v188, 16, v138
  v_and_b32 v189, 0xffff0000, v138
  v_lshlrev_b32 v190, 16, v139
  v_and_b32 v191, 0xffff0000, v139
  v_add_f32 v36, v176, v184
  v_add_f32 v37, v177, v185
  v_cvt_pk_bf16_f32 v164, v36, v37
  v_add_f32 v38, v178, v186
  s_barrier
  ds_write_b128 v9, v[20:23] offset:16512
  ds_write_b128 v9, v[24:27] offset:16576
  ds_write_b128 v9, v[28:31] offset:16640
  ds_write_b128 v9, v[32:35] offset:16704
  s_add_u32 m0, s33, 33024
  s_mov_b32 s34, 258048
  buffer_load_dwordx4 v18, s[44:47], s34 offen offset:0 sc1 lds
  buffer_load_dwordx4 v18, s[44:47], s34 offen offset:1024 sc1 lds
  buffer_load_dwordx4 v18, s[44:47], s34 offen offset:2048 sc1 lds
  s_waitcnt vmcnt(3) lgkmcnt(0)
  s_barrier
  s_add_u32 m0, s33, 36096
  s_mov_b32 s34, 331776
  buffer_load_dwordx4 v18, s[44:47], s34 offen offset:0 sc1 lds
  v_add_f32 v39, v179, v187
  v_cvt_pk_bf16_f32 v165, v38, v39
  v_add_f32 v36, v180, v188
  v_add_f32 v37, v181, v189
  v_cvt_pk_bf16_f32 v166, v36, v37
  buffer_load_dwordx4 v18, s[44:47], s34 offen offset:1024 sc1 lds
  v_add_f32 v38, v182, v190
  v_add_f32 v39, v183, v191
  v_cvt_pk_bf16_f32 v167, v38, v39
  v_sub_f32 v36, v184, v176
  v_sub_f32 v37, v185, v177
  v_cvt_pk_bf16_f32 v136, v36, v37
  buffer_load_dwordx4 v18, s[44:47], s34 offen offset:2048 sc1 lds
  v_sub_f32 v38, v186, v178
  v_sub_f32 v39, v187, v179
  v_cvt_pk_bf16_f32 v137, v38, v39
  v_sub_f32 v36, v188, v180
  v_sub_f32 v37, v189, v181
  s_add_u32 m0, s33, 39168
  s_mov_b32 s34, 405504
  buffer_load_dwordx4 v18, s[44:47], s34 offen offset:0 sc1 lds
  v_cvt_pk_bf16_f32 v138, v36, v37
  v_sub_f32 v38, v190, v182
  v_sub_f32 v39, v191, v183
  v_cvt_pk_bf16_f32 v139, v38, v39
  v_lshlrev_b32 v176, 16, v140
  buffer_load_dwordx4 v18, s[44:47], s34 offen offset:1024 sc1 lds
  v_and_b32 v177, 0xffff0000, v140
  v_lshlrev_b32 v178, 16, v141
  v_and_b32 v179, 0xffff0000, v141
  v_lshlrev_b32 v180, 16, v142
  v_and_b32 v181, 0xffff0000, v142
  v_lshlrev_b32 v182, 16, v143
  buffer_load_dwordx4 v18, s[44:47], s34 offen offset:2048 sc1 lds
  v_and_b32 v183, 0xffff0000, v143
  v_lshlrev_b32 v184, 16, v144
  v_and_b32 v185, 0xffff0000, v144
  v_lshlrev_b32 v186, 16, v145
  v_and_b32 v187, 0xffff0000, v145
  s_add_u32 m0, s33, 106752
  s_mov_b32 s34, 24576
  buffer_load_dwordx4 v18, s[44:47], s34 offen offset:0 sc1 lds
  v_lshlrev_b32 v188, 16, v146
  v_and_b32 v189, 0xffff0000, v146
  v_lshlrev_b32 v190, 16, v147
  v_and_b32 v191, 0xffff0000, v147
  v_add_f32 v36, v176, v184
  buffer_load_dwordx4 v18, s[44:47], s34 offen offset:1024 sc1 lds
  v_add_f32 v37, v177, v185
  v_cvt_pk_bf16_f32 v168, v36, v37
  v_add_f32 v38, v178, v186
  v_add_f32 v39, v179, v187
  v_cvt_pk_bf16_f32 v169, v38, v39
  v_add_f32 v36, v180, v188
  buffer_load_dwordx4 v18, s[44:47], s34 offen offset:2048 sc1 lds
  v_add_f32 v37, v181, v189
  v_cvt_pk_bf16_f32 v170, v36, v37
  v_add_f32 v38, v182, v190
  v_add_f32 v39, v183, v191
  v_cvt_pk_bf16_f32 v171, v38, v39
  s_add_u32 m0, s33, 109824
  s_mov_b32 s34, 98304
  buffer_load_dwordx4 v18, s[44:47], s34 offen offset:0 sc1 lds
  v_sub_f32 v36, v184, v176
  v_sub_f32 v37, v185, v177
  v_cvt_pk_bf16_f32 v144, v36, v37
  v_sub_f32 v38, v186, v178
  v_sub_f32 v39, v187, v179
  buffer_load_dwordx4 v18, s[44:47], s34 offen offset:1024 sc1 lds
  v_cvt_pk_bf16_f32 v145, v38, v39
  v_sub_f32 v36, v188, v180
  v_sub_f32 v37, v189, v181
  v_cvt_pk_bf16_f32 v146, v36, v37
  v_sub_f32 v38, v190, v182
  v_sub_f32 v39, v191, v183
  buffer_load_dwordx4 v18, s[44:47], s34 offen offset:2048 sc1 lds
  v_cvt_pk_bf16_f32 v147, v38, v39
  v_lshlrev_b32 v176, 16, v148
  v_and_b32 v177, 0xffff0000, v148
  v_lshlrev_b32 v178, 16, v149
  v_and_b32 v179, 0xffff0000, v149
  s_add_u32 m0, s33, 112896
  s_mov_b32 s34, 172032
  buffer_load_dwordx4 v18, s[44:47], s34 offen offset:0 sc1 lds
  v_lshlrev_b32 v180, 16, v150
  v_and_b32 v181, 0xffff0000, v150
  v_lshlrev_b32 v182, 16, v151
  v_and_b32 v183, 0xffff0000, v151
  v_lshlrev_b32 v184, 16, v152
  buffer_load_dwordx4 v18, s[44:47], s34 offen offset:1024 sc1 lds
  v_and_b32 v185, 0xffff0000, v152
  v_lshlrev_b32 v186, 16, v153
  v_and_b32 v187, 0xffff0000, v153
  v_lshlrev_b32 v188, 16, v154
  v_and_b32 v189, 0xffff0000, v154
  v_lshlrev_b32 v190, 16, v155
  buffer_load_dwordx4 v18, s[44:47], s34 offen offset:2048 sc1 lds
  v_and_b32 v191, 0xffff0000, v155
  v_add_f32 v36, v176, v184
  v_add_f32 v37, v177, v185
  v_cvt_pk_bf16_f32 v172, v36, v37
  v_add_f32 v38, v178, v186
  s_waitcnt vmcnt(9)
  s_barrier
  v_add_f32 v39, v179, v187
  v_cvt_pk_bf16_f32 v173, v38, v39
  v_add_f32 v36, v180, v188
  v_add_f32 v37, v181, v189
  v_cvt_pk_bf16_f32 v174, v36, v37
  v_add_f32 v38, v182, v190
  v_add_f32 v39, v183, v191
  v_cvt_pk_bf16_f32 v175, v38, v39
  v_sub_f32 v36, v184, v176
  v_sub_f32 v37, v185, v177
  v_cvt_pk_bf16_f32 v152, v36, v37
  v_sub_f32 v38, v186, v178
  v_sub_f32 v39, v187, v179
  v_cvt_pk_bf16_f32 v153, v38, v39
  v_sub_f32 v36, v188, v180
  v_sub_f32 v37, v189, v181
  v_cvt_pk_bf16_f32 v154, v36, v37
  v_sub_f32 v38, v190, v182
  v_sub_f32 v39, v191, v183
  v_cvt_pk_bf16_f32 v155, v38, v39
  v_lshlrev_b32 v176, 16, v44
  v_and_b32 v177, 0xffff0000, v44
  v_lshlrev_b32 v178, 16, v45
  v_and_b32 v179, 0xffff0000, v45
  v_lshlrev_b32 v180, 16, v46
  v_and_b32 v181, 0xffff0000, v46
  v_lshlrev_b32 v182, 16, v47
  v_and_b32 v183, 0xffff0000, v47
  v_lshlrev_b32 v184, 16, v52
  v_and_b32 v185, 0xffff0000, v52
  v_lshlrev_b32 v186, 16, v53
  v_and_b32 v187, 0xffff0000, v53
  v_lshlrev_b32 v188, 16, v54
  v_and_b32 v189, 0xffff0000, v54
  v_lshlrev_b32 v190, 16, v55
  v_and_b32 v191, 0xffff0000, v55
  v_sub_f32 v36, v184, v176
  v_sub_f32 v37, v185, v177
  v_cvt_pk_bf16_f32 v20, v36, v37
  v_sub_f32 v38, v186, v178
  v_sub_f32 v39, v187, v179
  v_cvt_pk_bf16_f32 v21, v38, v39
  v_sub_f32 v36, v188, v180
  v_sub_f32 v37, v189, v181
  v_cvt_pk_bf16_f32 v22, v36, v37
  v_sub_f32 v38, v190, v182
  v_sub_f32 v39, v191, v183
  v_cvt_pk_bf16_f32 v23, v38, v39
  v_lshlrev_b32 v176, 16, v60
  v_and_b32 v177, 0xffff0000, v60
  v_lshlrev_b32 v178, 16, v61
  v_and_b32 v179, 0xffff0000, v61
  v_lshlrev_b32 v180, 16, v62
  v_and_b32 v181, 0xffff0000, v62
  v_lshlrev_b32 v182, 16, v63
  v_and_b32 v183, 0xffff0000, v63
  v_sub_f32 v36, v176, v184
  v_sub_f32 v37, v177, v185
  v_cvt_pk_bf16_f32 v24, v36, v37
  v_sub_f32 v38, v178, v186
  v_sub_f32 v39, v179, v187
  v_cvt_pk_bf16_f32 v25, v38, v39
  v_sub_f32 v36, v180, v188
  v_sub_f32 v37, v181, v189
  s_barrier
  ds_write_b128 v9, v[88:91] offset:0
  ds_write_b128 v9, v[96:99] offset:64
  ds_write_b128 v9, v[104:107] offset:128
  ds_write_b128 v9, v[112:115] offset:192
  s_add_u32 m0, s33, 69888
  s_mov_b32 s34, 36864
  buffer_load_dwordx4 v18, s[44:47], s34 offen offset:0 sc1 lds
  buffer_load_dwordx4 v18, s[44:47], s34 offen offset:1024 sc1 lds
  buffer_load_dwordx4 v18, s[44:47], s34 offen offset:2048 sc1 lds
  s_waitcnt vmcnt(3) lgkmcnt(0)
  s_barrier
  s_add_u32 m0, s33, 72960
  s_mov_b32 s34, 110592
  buffer_load_dwordx4 v18, s[44:47], s34 offen offset:0 sc1 lds
  v_cvt_pk_bf16_f32 v26, v36, v37
  v_sub_f32 v38, v182, v190
  v_sub_f32 v39, v183, v191
  v_cvt_pk_bf16_f32 v27, v38, v39
  v_lshlrev_b32 v184, 16, v68
  v_and_b32 v185, 0xffff0000, v68
  buffer_load_dwordx4 v18, s[44:47], s34 offen offset:1024 sc1 lds
  v_lshlrev_b32 v186, 16, v69
  v_and_b32 v187, 0xffff0000, v69
  v_lshlrev_b32 v188, 16, v70
  v_and_b32 v189, 0xffff0000, v70
  v_lshlrev_b32 v190, 16, v71
  v_and_b32 v191, 0xffff0000, v71
  buffer_load_dwordx4 v18, s[44:47], s34 offen offset:2048 sc1 lds
  v_sub_f32 v36, v184, v176
  v_sub_f32 v37, v185, v177
  v_cvt_pk_bf16_f32 v28, v36, v37
  v_sub_f32 v38, v186, v178
  v_sub_f32 v39, v187, v179
  v_cvt_pk_bf16_f32 v29, v38, v39
  s_add_u32 m0, s33, 76032
  s_mov_b32 s34, 184320
  buffer_load_dwordx4 v18, s[44:47], s34 offen offset:0 sc1 lds
  v_sub_f32 v36, v188, v180
  v_sub_f32 v37, v189, v181
  v_cvt_pk_bf16_f32 v30, v36, v37
  v_sub_f32 v38, v190, v182
  v_sub_f32 v39, v191, v183
  buffer_load_dwordx4 v18, s[44:47], s34 offen offset:1024 sc1 lds
  v_cvt_pk_bf16_f32 v31, v38, v39
  v_lshlrev_b32 v176, 16, v76
  v_and_b32 v177, 0xffff0000, v76
  v_lshlrev_b32 v178, 16, v77
  v_and_b32 v179, 0xffff0000, v77
  v_lshlrev_b32 v180, 16, v78
  buffer_load_dwordx4 v18, s[44:47], s34 offen offset:2048 sc1 lds
  v_and_b32 v181, 0xffff0000, v78
  v_lshlrev_b32 v182, 16, v79
  v_and_b32 v183, 0xffff0000, v79
  v_sub_f32 v36, v176, v184
  v_sub_f32 v37, v177, v185
  v_cvt_pk_bf16_f32 v32, v36, v37
  s_add_u32 m0, s33, 33024
  s_mov_b32 s34, 49152
  buffer_load_dwordx4 v18, s[44:47], s34 offen offset:0 sc1 lds
  v_sub_f32 v38, v178, v186
  v_sub_f32 v39, v179, v187
  v_cvt_pk_bf16_f32 v33, v38, v39
  v_sub_f32 v36, v180, v188
  v_sub_f32 v37, v181, v189
  v_cvt_pk_bf16_f32 v34, v36, v37
  buffer_load_dwordx4 v18, s[44:47], s34 offen offset:1024 sc1 lds
  v_sub_f32 v38, v182, v190
  v_sub_f32 v39, v183, v191
  v_cvt_pk_bf16_f32 v35, v38, v39
  v_lshlrev_b32 v176, 16, v124
  v_and_b32 v177, 0xffff0000, v124
  v_lshlrev_b32 v178, 16, v125
  buffer_load_dwordx4 v18, s[44:47], s34 offen offset:2048 sc1 lds
  v_and_b32 v179, 0xffff0000, v125
  v_lshlrev_b32 v180, 16, v126
  v_and_b32 v181, 0xffff0000, v126
  v_lshlrev_b32 v182, 16, v127
  v_and_b32 v183, 0xffff0000, v127
  v_lshlrev_b32 v184, 16, v132
  s_add_u32 m0, s33, 36096
  s_mov_b32 s34, 122880
  buffer_load_dwordx4 v18, s[44:47], s34 offen offset:0 sc1 lds
  v_and_b32 v185, 0xffff0000, v132
  v_lshlrev_b32 v186, 16, v133
  v_and_b32 v187, 0xffff0000, v133
  v_lshlrev_b32 v188, 16, v134
  v_and_b32 v189, 0xffff0000, v134
  v_lshlrev_b32 v190, 16, v135
  buffer_load_dwordx4 v18, s[44:47], s34 offen offset:1024 sc1 lds
  v_and_b32 v191, 0xffff0000, v135
  v_sub_f32 v36, v184, v176
  v_sub_f32 v37, v185, v177
  v_cvt_pk_bf16_f32 v48, v36, v37
  v_sub_f32 v38, v186, v178
  v_sub_f32 v39, v187, v179
  buffer_load_dwordx4 v18, s[44:47], s34 offen offset:2048 sc1 lds
  v_cvt_pk_bf16_f32 v49, v38, v39
  v_sub_f32 v36, v188, v180
  v_sub_f32 v37, v189, v181
  v_cvt_pk_bf16_f32 v50, v36, v37
  v_sub_f32 v38, v190, v182
  s_add_u32 m0, s33, 39168
  s_mov_b32 s34, 196608
  buffer_load_dwordx4 v18, s[44:47], s34 offen offset:0 sc1 lds
  v_sub_f32 v39, v191, v183
  v_cvt_pk_bf16_f32 v51, v38, v39
  v_lshlrev_b32 v176, 16, v140
  v_and_b32 v177, 0xffff0000, v140
  v_lshlrev_b32 v178, 16, v141
  v_and_b32 v179, 0xffff0000, v141
  buffer_load_dwordx4 v18, s[44:47], s34 offen offset:1024 sc1 lds
  v_lshlrev_b32 v180, 16, v142
  v_and_b32 v181, 0xffff0000, v142
  v_lshlrev_b32 v182, 16, v143
  v_and_b32 v183, 0xffff0000, v143
  v_sub_f32 v36, v176, v184
  v_sub_f32 v37, v177, v185
  buffer_load_dwordx4 v18, s[44:47], s34 offen offset:2048 sc1 lds
  v_cvt_pk_bf16_f32 v56, v36, v37
  v_sub_f32 v38, v178, v186
  v_sub_f32 v39, v179, v187
  v_cvt_pk_bf16_f32 v57, v38, v39
  v_sub_f32 v36, v180, v188
  v_sub_f32 v37, v181, v189
  s_waitcnt vmcnt(9)
  s_barrier
  v_cvt_pk_bf16_f32 v58, v36, v37
  v_sub_f32 v38, v182, v190
  v_sub_f32 v39, v183, v191
  v_cvt_pk_bf16_f32 v59, v38, v39
  v_lshlrev_b32 v184, 16, v148
  v_and_b32 v185, 0xffff0000, v148
  v_lshlrev_b32 v186, 16, v149
  v_and_b32 v187, 0xffff0000, v149
  v_lshlrev_b32 v188, 16, v150
  v_and_b32 v189, 0xffff0000, v150
  v_lshlrev_b32 v190, 16, v151
  v_and_b32 v191, 0xffff0000, v151
  v_sub_f32 v36, v184, v176
  v_sub_f32 v37, v185, v177
  v_cvt_pk_bf16_f32 v64, v36, v37
  v_sub_f32 v38, v186, v178
  v_sub_f32 v39, v187, v179
  v_cvt_pk_bf16_f32 v65, v38, v39
  v_sub_f32 v36, v188, v180
  v_sub_f32 v37, v189, v181
  v_cvt_pk_bf16_f32 v66, v36, v37
  v_sub_f32 v38, v190, v182
  v_sub_f32 v39, v191, v183
  v_cvt_pk_bf16_f32 v67, v38, v39
  v_lshlrev_b32 v176, 16, v156
  v_and_b32 v177, 0xffff0000, v156
  v_lshlrev_b32 v178, 16, v157
  v_and_b32 v179, 0xffff0000, v157
  v_lshlrev_b32 v180, 16, v158
  v_and_b32 v181, 0xffff0000, v158
  v_lshlrev_b32 v182, 16, v159
  v_and_b32 v183, 0xffff0000, v159
  v_sub_f32 v36, v176, v184
  v_sub_f32 v37, v177, v185
  v_cvt_pk_bf16_f32 v72, v36, v37
  v_sub_f32 v38, v178, v186
  v_sub_f32 v39, v179, v187
  v_cvt_pk_bf16_f32 v73, v38, v39
  v_sub_f32 v36, v180, v188
  v_sub_f32 v37, v181, v189
  v_cvt_pk_bf16_f32 v74, v36, v37
  v_sub_f32 v38, v182, v190
  v_sub_f32 v39, v183, v191
  v_cvt_pk_bf16_f32 v75, v38, v39
  s_barrier
  ds_write_b128 v9, v[160:163] offset:16512
  ds_write_b128 v9, v[164:167] offset:16576
  ds_write_b128 v9, v[168:171] offset:16640
  ds_write_b128 v9, v[172:175] offset:16704
  s_add_u32 m0, s33, 106752
  s_mov_b32 s34, 61440
  buffer_load_dwordx4 v18, s[44:47], s34 offen offset:0 sc1 lds
  buffer_load_dwordx4 v18, s[44:47], s34 offen offset:1024 sc1 lds
  buffer_load_dwordx4 v18, s[44:47], s34 offen offset:2048 sc1 lds
  s_waitcnt vmcnt(3) lgkmcnt(0)
  s_barrier
  s_add_u32 m0, s33, 109824
  s_mov_b32 s34, 135168
  buffer_load_dwordx4 v18, s[44:47], s34 offen offset:0 sc1 lds
  v_lshlrev_b32 v176, 16, v84
  v_and_b32 v177, 0xffff0000, v84
  v_lshlrev_b32 v178, 16, v85
  v_and_b32 v179, 0xffff0000, v85
  buffer_load_dwordx4 v18, s[44:47], s34 offen offset:1024 sc1 lds
  v_lshlrev_b32 v180, 16, v86
  v_and_b32 v181, 0xffff0000, v86
  v_lshlrev_b32 v182, 16, v87
  v_and_b32 v183, 0xffff0000, v87
  v_lshlrev_b32 v184, 16, v92
  buffer_load_dwordx4 v18, s[44:47], s34 offen offset:2048 sc1 lds
  v_and_b32 v185, 0xffff0000, v92
  v_lshlrev_b32 v186, 16, v93
  v_and_b32 v187, 0xffff0000, v93
  v_lshlrev_b32 v188, 16, v94
  s_add_u32 m0, s33, 112896
  s_mov_b32 s34, 208896
  buffer_load_dwordx4 v18, s[44:47], s34 offen offset:0 sc1 lds
  v_and_b32 v189, 0xffff0000, v94
  v_lshlrev_b32 v190, 16, v95
  v_and_b32 v191, 0xffff0000, v95
  v_sub_f32 v36, v184, v176
  v_sub_f32 v37, v185, v177
  buffer_load_dwordx4 v18, s[44:47], s34 offen offset:1024 sc1 lds
  v_cvt_pk_bf16_f32 v160, v36, v37
  v_sub_f32 v38, v186, v178
  v_sub_f32 v39, v187, v179
  v_cvt_pk_bf16_f32 v161, v38, v39
  buffer_load_dwordx4 v18, s[44:47], s34 offen offset:2048 sc1 lds
  v_sub_f32 v36, v188, v180
  v_sub_f32 v37, v189, v181
  v_cvt_pk_bf16_f32 v162, v36, v37
  v_sub_f32 v38, v190, v182
  s_add_u32 m0, s33, 69888
  s_mov_b32 s34, 270336
  buffer_load_dwordx4 v18, s[44:47], s34 offen offset:0 sc1 lds
  v_sub_f32 v39, v191, v183
  v_cvt_pk_bf16_f32 v163, v38, v39
  v_lshlrev_b32 v176, 16, v100
  v_and_b32 v177, 0xffff0000, v100
  v_lshlrev_b32 v178, 16, v101
  buffer_load_dwordx4 v18, s[44:47], s34 offen offset:1024 sc1 lds
  v_and_b32 v179, 0xffff0000, v101
  v_lshlrev_b32 v180, 16, v102
  v_and_b32 v181, 0xffff0000, v102
  v_lshlrev_b32 v182, 16, v103
  buffer_load_dwordx4 v18, s[44:47], s34 offen offset:2048 sc1 lds
  v_and_b32 v183, 0xffff0000, v103
  v_sub_f32 v36, v176, v184
  v_sub_f32 v37, v177, v185
  v_cvt_pk_bf16_f32 v164, v36, v37
  v_sub_f32 v38, v178, v186
  s_add_u32 m0, s33, 72960
  s_mov_b32 s34, 344064
  buffer_load_dwordx4 v18, s[44:47], s34 offen offset:0 sc1 lds
  v_sub_f32 v39, v179, v187
  v_cvt_pk_bf16_f32 v165, v38, v39
  v_sub_f32 v36, v180, v188
  v_sub_f32 v37, v181, v189
  buffer_load_dwordx4 v18, s[44:47], s34 offen offset:1024 sc1 lds
  v_cvt_pk_bf16_f32 v166, v36, v37
  v_sub_f32 v38, v182, v190
  v_sub_f32 v39, v183, v191
  v_cvt_pk_bf16_f32 v167, v38, v39
  buffer_load_dwordx4 v18, s[44:47], s34 offen offset:2048 sc1 lds
  v_lshlrev_b32 v184, 16, v108
  v_and_b32 v185, 0xffff0000, v108
  v_lshlrev_b32 v186, 16, v109
  v_and_b32 v187, 0xffff0000, v109
  v_lshlrev_b32 v188, 16, v110
  s_add_u32 m0, s33, 76032
  s_mov_b32 s34, 417792
  buffer_load_dwordx4 v18, s[44:47], s34 offen offset:0 sc1 lds
  v_and_b32 v189, 0xffff0000, v110
  v_lshlrev_b32 v190, 16, v111
  v_and_b32 v191, 0xffff0000, v111
  v_sub_f32 v36, v184, v176
  s_branch L_po7
L_pg7:
  s_branch L_pr7
L_po7:
  buffer_load_dwordx4 v18, s[44:47], s34 offen offset:1024 sc1 lds
  v_sub_f32 v37, v185, v177
  v_cvt_pk_bf16_f32 v168, v36, v37
  v_sub_f32 v38, v186, v178
  v_sub_f32 v39, v187, v179
  v_cvt_pk_bf16_f32 v169, v38, v39
  buffer_load_dwordx4 v18, s[44:47], s34 offen offset:2048 sc1 lds
  v_sub_f32 v36, v188, v180
  v_sub_f32 v37, v189, v181
  v_cvt_pk_bf16_f32 v170, v36, v37
  v_sub_f32 v38, v190, v182
  s_waitcnt vmcnt(9)
  s_barrier
  v_sub_f32 v39, v191, v183
  v_cvt_pk_bf16_f32 v171, v38, v39
  v_lshlrev_b32 v176, 16, v116
  v_and_b32 v177, 0xffff0000, v116
  v_lshlrev_b32 v178, 16, v117
  v_and_b32 v179, 0xffff0000, v117
  v_lshlrev_b32 v180, 16, v118
  v_and_b32 v181, 0xffff0000, v118
  v_lshlrev_b32 v182, 16, v119
  v_and_b32 v183, 0xffff0000, v119
  v_sub_f32 v36, v176, v184
  v_sub_f32 v37, v177, v185
  v_cvt_pk_bf16_f32 v172, v36, v37
  v_sub_f32 v38, v178, v186
  v_sub_f32 v39, v179, v187
  v_cvt_pk_bf16_f32 v173, v38, v39
  v_sub_f32 v36, v180, v188
  v_sub_f32 v37, v181, v189
  v_cvt_pk_bf16_f32 v174, v36, v37
  v_sub_f32 v38, v182, v190
  v_sub_f32 v39, v183, v191
  v_cvt_pk_bf16_f32 v175, v38, v39
  v_and_b32 v16, 1, v2
  v_mul_u32_u24 v16, 192, v16
  v_add_u32 v16, v16, v1
  v_lshrrev_b32 v17, 1, v2
  v_mul_u32_u24 v192, 6272, v17
  s_mov_b32 s36, 86016
  v_mul_u32_u24 v193, s36, v17
  v_lshlrev_b32 v193, 1, v193
  v_add_u32 v7, 0, v16
  v_mul_u32_u24 v6, 2731, v7
  v_lshrrev_b32 v6, 16, v6
  v_lshl_add_u32 v194, v7, 1, v6
  v_lshl_add_u32 v10, v194, 3, v192
  v_mul_u32_u24 v194, 24, v6
  v_sub_u32 v194, v7, v194
  v_lshl_add_u32 v194, v194, 4, v193
  v_lshrrev_b32 v195, 3, v6
  v_mad_u32_u24 v194, v195, s36, v194
  v_and_b32 v195, 7, v6
  v_mul_u32_u24 v195, 768, v195
  v_add_u32 v13, v194, v195
  v_add_u32 v7, 64, v16
  v_mul_u32_u24 v6, 2731, v7
  v_lshrrev_b32 v6, 16, v6
  v_lshl_add_u32 v194, v7, 1, v6
  v_lshl_add_u32 v11, v194, 3, v192
  v_mul_u32_u24 v194, 24, v6
  v_sub_u32 v194, v7, v194
  v_lshl_add_u32 v194, v194, 4, v193
  v_lshrrev_b32 v195, 3, v6
  v_mad_u32_u24 v194, v195, s36, v194
  v_and_b32 v195, 7, v6
  v_mul_u32_u24 v195, 768, v195
  v_add_u32 v14, v194, v195
  v_add_u32 v7, 128, v16
  v_mul_u32_u24 v6, 2731, v7
  v_lshrrev_b32 v6, 16, v6
  v_lshl_add_u32 v194, v7, 1, v6
  v_lshl_add_u32 v12, v194, 3, v192
  v_mul_u32_u24 v194, 24, v6
  v_sub_u32 v194, v7, v194
  v_lshl_add_u32 v194, v194, 4, v193
  v_lshrrev_b32 v195, 3, v6
  v_mad_u32_u24 v194, v195, s36, v194
  v_and_b32 v195, 7, v6
  v_mul_u32_u24 v195, 768, v195
  v_add_u32 v15, v194, v195
  v_add_u32 v10, 137344, v10
  v_add_u32 v11, 137344, v11
  v_add_u32 v12, 137344, v12
  s_mul_i32 s37, s29, 224
  s_add_u32 s37, s37, s30
  s_mul_i32 s37, s37, 384
  s_barrier
  ds_write_b128 v9, v[128:131] offset:0
  ds_write_b128 v9, v[136:139] offset:64
  ds_write_b128 v9, v[144:147] offset:128
  ds_write_b128 v9, v[152:155] offset:192
  s_add_u32 m0, s33, 33024
  s_mov_b32 s34, 282624
  buffer_load_dwordx4 v18, s[44:47], s34 offen offset:0 sc1 lds
  buffer_load_dwordx4 v18, s[44:47], s34 offen offset:1024 sc1 lds
  buffer_load_dwordx4 v18, s[44:47], s34 offen offset:2048 sc1 lds
  s_waitcnt vmcnt(3) lgkmcnt(0)
  s_barrier
  s_add_u32 m0, s33, 36096
  s_mov_b32 s34, 356352
  buffer_load_dwordx4 v18, s[44:47], s34 offen offset:0 sc1 lds
  buffer_load_dwordx4 v18, s[44:47], s34 offen offset:1024 sc1 lds
  buffer_load_dwordx4 v18, s[44:47], s34 offen offset:2048 sc1 lds
  s_add_u32 m0, s33, 39168
  s_mov_b32 s34, 430080
  buffer_load_dwordx4 v18, s[44:47], s34 offen offset:0 sc1 lds
  buffer_load_dwordx4 v18, s[44:47], s34 offen offset:1024 sc1 lds
  buffer_load_dwordx4 v18, s[44:47], s34 offen offset:2048 sc1 lds
  s_add_u32 m0, s33, 106752
  s_mov_b32 s34, 147456
  buffer_load_dwordx4 v3, s[16:19], s34 offen offset:0 lds
  buffer_load_dwordx4 v4, s[16:19], s34 offen offset:1024 lds
  buffer_load_dwordx4 v5, s[16:19], s34 offen offset:2048 lds
  s_add_u32 m0, s33, 109824
  s_mov_b32 s34, 368640
  buffer_load_dwordx4 v3, s[16:19], s34 offen offset:0 lds
  buffer_load_dwordx4 v4, s[16:19], s34 offen offset:1024 lds
  buffer_load_dwordx4 v5, s[16:19], s34 offen offset:2048 lds
  s_add_u32 m0, s33, 112896
  s_mov_b32 s34, 589824
  buffer_load_dwordx4 v3, s[16:19], s34 offen offset:0 lds
  buffer_load_dwordx4 v4, s[16:19], s34 offen offset:1024 lds
  buffer_load_dwordx4 v5, s[16:19], s34 offen offset:2048 lds
  s_waitcnt vmcnt(9)
  s_barrier
  s_barrier
  ds_write_b128 v9, v[20:23] offset:16512
  ds_write_b128 v9, v[24:27] offset:16576
  ds_write_b128 v9, v[28:31] offset:16640
  ds_write_b128 v9, v[32:35] offset:16704
  s_add_u32 m0, s33, 69888
  s_mov_b32 s34, 159744
  buffer_load_dwordx4 v3, s[16:19], s34 offen offset:0 lds
  buffer_load_dwordx4 v4, s[16:19], s34 offen offset:1024 lds
  buffer_load_dwordx4 v5, s[16:19], s34 offen offset:2048 lds
  s_waitcnt vmcnt(3) lgkmcnt(0)
  s_barrier
  s_add_u32 m0, s33, 72960
  s_mov_b32 s34, 380928
  buffer_load_dwordx4 v3, s[16:19], s34 offen offset:0 lds
  buffer_load_dwordx4 v4, s[16:19], s34 offen offset:1024 lds
  buffer_load_dwordx4 v5, s[16:19], s34 offen offset:2048 lds
  s_add_u32 m0, s33, 76032
  s_mov_b32 s34, 602112
  buffer_load_dwordx4 v3, s[16:19], s34 offen offset:0 lds
  buffer_load_dwordx4 v4, s[16:19], s34 offen offset:1024 lds
  buffer_load_dwordx4 v5, s[16:19], s34 offen offset:2048 lds
  s_add_u32 m0, s33, 33024
  s_mov_b32 s34, 172032
  buffer_load_dwordx4 v3, s[16:19], s34 offen offset:0 lds
  buffer_load_dwordx4 v4, s[16:19], s34 offen offset:1024 lds
  buffer_load_dwordx4 v5, s[16:19], s34 offen offset:2048 lds
  s_add_u32 m0, s33, 36096
  s_mov_b32 s34, 393216
  buffer_load_dwordx4 v3, s[16:19], s34 offen offset:0 lds
  buffer_load_dwordx4 v4, s[16:19], s34 offen offset:1024 lds
  buffer_load_dwordx4 v5, s[16:19], s34 offen offset:2048 lds
  s_add_u32 m0, s33, 39168
  s_mov_b32 s34, 614400
  buffer_load_dwordx4 v3, s[16:19], s34 offen offset:0 lds
  buffer_load_dwordx4 v4, s[16:19], s34 offen offset:1024 lds
  buffer_load_dwordx4 v5, s[16:19], s34 offen offset:2048 lds
  s_waitcnt vmcnt(9)
  s_barrier
  s_barrier
  ds_write_b128 v9, v[160:163] offset:0
  ds_write_b128 v9, v[164:167] offset:64
  ds_write_b128 v9, v[168:171] offset:128
  ds_write_b128 v9, v[172:175] offset:192
  s_add_u32 m0, s33, 106752
  s_mov_b32 s34, 184320
  buffer_load_dwordx4 v3, s[16:19], s34 offen offset:0 lds
  buffer_load_dwordx4 v4, s[16:19], s34 offen offset:1024 lds
  s_waitcnt vmcnt(2) lgkmcnt(0)
  s_barrier
  s_add_u32 m0, s33, 106752
  s_mov_b32 s34, 184320
  buffer_load_dwordx4 v5, s[16:19], s34 offen offset:2048 lds
  s_add_u32 m0, s33, 109824
  s_mov_b32 s34, 405504
  buffer_load_dwordx4 v3, s[16:19], s34 offen offset:0 lds
  buffer_load_dwordx4 v4, s[16:19], s34 offen offset:1024 lds
  buffer_load_dwordx4 v5, s[16:19], s34 offen offset:2048 lds
  s_add_u32 m0, s33, 112896
  s_mov_b32 s34, 626688
  buffer_load_dwordx4 v3, s[16:19], s34 offen offset:0 lds
  buffer_load_dwordx4 v4, s[16:19], s34 offen offset:1024 lds
  buffer_load_dwordx4 v5, s[16:19], s34 offen offset:2048 lds
  s_add_u32 m0, s33, 69888
  s_mov_b32 s34, 196608
  buffer_load_dwordx4 v3, s[16:19], s34 offen offset:0 lds
  buffer_load_dwordx4 v4, s[16:19], s34 offen offset:1024 lds
  buffer_load_dwordx4 v5, s[16:19], s34 offen offset:2048 lds
  s_add_u32 m0, s33, 72960
  s_mov_b32 s34, 417792
  buffer_load_dwordx4 v3, s[16:19], s34 offen offset:0 lds
  buffer_load_dwordx4 v4, s[16:19], s34 offen offset:1024 lds
  buffer_load_dwordx4 v5, s[16:19], s34 offen offset:2048 lds
  s_add_u32 m0, s33, 76032
  s_mov_b32 s34, 638976
  buffer_load_dwordx4 v3, s[16:19], s34 offen offset:0 lds
  buffer_load_dwordx4 v4, s[16:19], s34 offen offset:1024 lds
  buffer_load_dwordx4 v5, s[16:19], s34 offen offset:2048 lds
  ds_read_b64 v[80:81], v10 offset:6272
  ds_read_b64 v[82:83], v10 offset:6280
  ds_read_b64 v[88:89], v11 offset:6272
  ds_read_b64 v[90:91], v11 offset:6280
  ds_read_b64 v[96:97], v12 offset:6272
  ds_read_b64 v[98:99], v12 offset:6280
  s_cmp_ge_u32 s28, 18432
  s_cbranch_scc1 L_sga10_2
  ds_read_b64 v[120:121], v10 offset:18816
  ds_read_b64 v[122:123], v10 offset:18824
  ds_read_b64 v[128:129], v11 offset:18816
  ds_read_b64 v[130:131], v11 offset:18824
  ds_read_b64 v[136:137], v12 offset:18816
  ds_read_b64 v[138:139], v12 offset:18824
L_sga10_2:
  s_waitcnt lgkmcnt(0)
  s_waitcnt vmcnt(9)
  s_barrier
  s_add_u32 s38, s37, 0
  buffer_store_dwordx4 v[80:83], v13, s[20:23], s38 offen sc1 nt
  buffer_store_dwordx4 v[88:91], v14, s[20:23], s38 offen sc1 nt
  buffer_store_dwordx4 v[96:99], v15, s[20:23], s38 offen sc1 nt
  s_cmp_ge_u32 s28, 18432
  s_cbranch_scc1 L_sga01_2
  s_add_u32 s38, s37, 344064
  buffer_store_dwordx4 v[120:123], v13, s[20:23], s38 offen sc1 nt
  buffer_store_dwordx4 v[128:131], v14, s[20:23], s38 offen sc1 nt
  buffer_store_dwordx4 v[136:139], v15, s[20:23], s38 offen sc1 nt
L_sga01_2:
  s_barrier
  ds_write_b128 v9, v[48:51] offset:16512
  ds_write_b128 v9, v[56:59] offset:16576
  ds_write_b128 v9, v[64:67] offset:16640
  ds_write_b128 v9, v[72:75] offset:16704
  s_add_u32 m0, s33, 33024
  s_mov_b32 s34, 208896
  buffer_load_dwordx4 v3, s[16:19], s34 offen offset:0 lds
  buffer_load_dwordx4 v4, s[16:19], s34 offen offset:1024 lds
  s_cmp_ge_u32 s28, 18432
  s_cbranch_scc1 L_bw21
  s_waitcnt vmcnt(8) lgkmcnt(0)
  s_branch L_bx21
L_bw21:
  s_waitcnt vmcnt(5) lgkmcnt(0)
L_bx21:
  s_barrier
  s_add_u32 m0, s33, 33024
  s_mov_b32 s34, 208896
  buffer_load_dwordx4 v5, s[16:19], s34 offen offset:2048 lds
  s_add_u32 m0, s33, 36096
  s_mov_b32 s34, 430080
  buffer_load_dwordx4 v3, s[16:19], s34 offen offset:0 lds
  buffer_load_dwordx4 v4, s[16:19], s34 offen offset:1024 lds
  buffer_load_dwordx4 v5, s[16:19], s34 offen offset:2048 lds
  s_add_u32 m0, s33, 39168
  s_mov_b32 s34, 651264
  buffer_load_dwordx4 v3, s[16:19], s34 offen offset:0 lds
  buffer_load_dwordx4 v4, s[16:19], s34 offen offset:1024 lds
  buffer_load_dwordx4 v5, s[16:19], s34 offen offset:2048 lds
  ds_read_b64 v[104:105], v10 offset:6272
  ds_read_b64 v[106:107], v10 offset:6280
  ds_read_b64 v[112:113], v11 offset:6272
  ds_read_b64 v[114:115], v11 offset:6280
  ds_read_b64 v[40:41], v12 offset:6272
  ds_read_b64 v[42:43], v12 offset:6280
  s_add_u32 s38, s37, 688128
  s_waitcnt lgkmcnt(4)
  buffer_store_dwordx4 v[104:107], v13, s[20:23], s38 offen sc1 nt
  s_waitcnt lgkmcnt(2)
  buffer_store_dwordx4 v[112:115], v14, s[20:23], s38 offen sc1 nt
  s_waitcnt lgkmcnt(0)
  buffer_store_dwordx4 v[40:43], v15, s[20:23], s38 offen sc1 nt
  s_cmp_ge_u32 s28, 18432
  s_cbranch_scc1 L_sgb11_3
  ds_read_b64 v[144:145], v10 offset:18816
  ds_read_b64 v[146:147], v10 offset:18824
  ds_read_b64 v[152:153], v11 offset:18816
  ds_read_b64 v[154:155], v11 offset:18824
  ds_read_b64 v[160:161], v12 offset:18816
  ds_read_b64 v[162:163], v12 offset:18824
  s_add_u32 s38, s37, 516096
  s_waitcnt lgkmcnt(4)
  buffer_store_dwordx4 v[144:147], v13, s[20:23], s38 offen sc1 nt
  s_waitcnt lgkmcnt(2)
  buffer_store_dwordx4 v[152:155], v14, s[20:23], s38 offen sc1 nt
  s_waitcnt lgkmcnt(0)
  buffer_store_dwordx4 v[160:163], v15, s[20:23], s38 offen sc1 nt
L_sgb11_3:
  s_cmp_ge_u32 s28, 18432
  s_cbranch_scc1 L_bw22
  s_waitcnt vmcnt(6)
  s_branch L_bx22
L_bw22:
  s_waitcnt vmcnt(3)
L_bx22:
  s_barrier
  s_cmp_ge_u32 s28, 18432
  s_cbranch_scc1 L_sgc11_6
  ds_read_b64 v[20:21], v10 offset:0
  ds_read_b64 v[22:23], v10 offset:8
  ds_read_b64 v[24:25], v11 offset:0
  ds_read_b64 v[26:27], v11 offset:8
  ds_read_b64 v[28:29], v12 offset:0
  ds_read_b64 v[30:31], v12 offset:8
  s_add_u32 s38, s37, 1032192
  s_waitcnt lgkmcnt(4)
  buffer_store_dwordx4 v[20:23], v13, s[20:23], s38 offen sc1 nt
  s_waitcnt lgkmcnt(2)
  buffer_store_dwordx4 v[24:27], v14, s[20:23], s38 offen sc1 nt
  s_waitcnt lgkmcnt(0)
  buffer_store_dwordx4 v[28:31], v15, s[20:23], s38 offen sc1 nt
L_sgc11_6:
  s_waitcnt lgkmcnt(0)
  v_add_u32 v10, 4294899840, v10
  v_add_u32 v11, 4294899840, v11
  v_add_u32 v12, 4294899840, v12
  s_barrier
  ds_read_b64 v[44:45], v10 offset:0
  ds_read_b64 v[46:47], v10 offset:8
  ds_read_b64 v[52:53], v11 offset:0
  ds_read_b64 v[54:55], v11 offset:8
  ds_read_b64 v[60:61], v12 offset:0
  ds_read_b64 v[62:63], v12 offset:8
  s_add_u32 s38, s37, 384
  s_waitcnt lgkmcnt(4)
  buffer_store_dwordx4 v[44:47], v13, s[20:23], s38 offen sc1 nt
  s_waitcnt lgkmcnt(2)
  buffer_store_dwordx4 v[52:55], v14, s[20:23], s38 offen sc1 nt
  s_waitcnt lgkmcnt(0)
  buffer_store_dwordx4 v[60:63], v15, s[20:23], s38 offen sc1 nt
  s_barrier
  ds_read_b64 v[84:85], v10 offset:12544
  ds_read_b64 v[86:87], v10 offset:12552
  ds_read_b64 v[92:93], v11 offset:12544
  ds_read_b64 v[94:95], v11 offset:12552
  ds_read_b64 v[100:101], v12 offset:12544
  ds_read_b64 v[102:103], v12 offset:12552
  s_add_u32 s38, s37, 344448
  s_waitcnt lgkmcnt(4)
  buffer_store_dwordx4 v[84:87], v13, s[20:23], s38 offen sc1 nt
  s_waitcnt lgkmcnt(2)
  buffer_store_dwordx4 v[92:95], v14, s[20:23], s38 offen sc1 nt
  s_waitcnt lgkmcnt(0)
  buffer_store_dwordx4 v[100:103], v15, s[20:23], s38 offen sc1 nt
  s_barrier
  ds_read_b64 v[124:125], v10 offset:25088
  ds_read_b64 v[126:127], v10 offset:25096
  ds_read_b64 v[132:133], v11 offset:25088
  ds_read_b64 v[134:135], v11 offset:25096
  ds_read_b64 v[140:141], v12 offset:25088
  ds_read_b64 v[142:143], v12 offset:25096
  s_add_u32 s38, s37, 688512
  s_waitcnt lgkmcnt(4)
  buffer_store_dwordx4 v[124:127], v13, s[20:23], s38 offen sc1 nt
  s_waitcnt lgkmcnt(2)
  buffer_store_dwordx4 v[132:135], v14, s[20:23], s38 offen sc1 nt
  s_waitcnt lgkmcnt(0)
  buffer_store_dwordx4 v[140:143], v15, s[20:23], s38 offen sc1 nt
  s_barrier
  s_cmp_ge_u32 s28, 18432
  s_cbranch_scc1 L_sgy11_6
  ds_read_b64 v[68:69], v10 offset:37632
  ds_read_b64 v[70:71], v10 offset:37640
  ds_read_b64 v[108:109], v11 offset:37632
  ds_read_b64 v[110:111], v11 offset:37640
  ds_read_b64 v[148:149], v12 offset:37632
  ds_read_b64 v[150:151], v12 offset:37640
  s_add_u32 s38, s37, 1032576
  s_waitcnt lgkmcnt(4)
  buffer_store_dwordx4 v[68:71], v13, s[20:23], s38 offen sc1 nt
  s_waitcnt lgkmcnt(2)
  buffer_store_dwordx4 v[108:111], v14, s[20:23], s38 offen sc1 nt
  s_waitcnt lgkmcnt(0)
  buffer_store_dwordx4 v[148:151], v15, s[20:23], s38 offen sc1 nt
L_sgy11_6:
  s_endpgm
L_end:
  s_endpgm
.section .rodata,"a"
.p2align 6
.amdhsa_kernel standalone__standard_2d_1d_3d_conv__vision_kernel
  .amdhsa_next_free_vgpr 256
  .amdhsa_next_free_sgpr 102
  .amdhsa_accum_offset 196
  .amdhsa_group_segment_fixed_size 0
  .amdhsa_kernarg_size 48
  .amdhsa_user_sgpr_count 2
  .amdhsa_user_sgpr_kernarg_segment_ptr 1
  .amdhsa_system_sgpr_workgroup_id_x 1
.end_amdhsa_kernel
```
